```python
import torch

def _softmax(x, axis=-1):
    return torch.softmax(x, dim=axis)
def _gelu(x):
    return torch.nn.functional.gelu(x, approximate="tanh")
def _silu(x):
    return torch.nn.functional.silu(x)
def _sigmoid(x):
    return torch.sigmoid(x)
def _layernorm(x, axis=-1, eps=1e-5):
    m = x.mean(dim=axis, keepdim=True)
    v = x.var(dim=axis, keepdim=True, unbiased=False)
    return (x - m) / torch.sqrt(v + eps)
def _scatter_add(tgt, idx, src, axis=0):
    return tgt.clone().index_add_(axis, idx, src)
def _segment_sum(src, seg, n):
    out = torch.zeros((n,) + src.shape[1:], dtype=src.dtype)
    return out.index_add_(0, seg, src)
def _pad(x, pw):
    flat = tuple(v for pair in reversed(pw) for v in pair)
    return torch.nn.functional.pad(x, flat)

kernel_name = 'standalone__mha_block_cached__near_ridge'

def setup_inputs():

    _w = (lambda a: (lambda t: t.to(torch.bfloat16) if t.is_floating_point() else t)(torch.as_tensor(a)))
    B, Sq, D = 8, 144, 576
    H, Sk, Dh = 32, 512, 128
    return {
        "x": _w((lambda *s: torch.randn(*s, dtype=torch.bfloat16) * 0.8)(B, Sq, D)),
        "k_cache": _w((lambda *s: torch.randn(*s, dtype=torch.bfloat16) * 0.8)(B, H, Sk, Dh)),
        "v_cache": _w((lambda *s: torch.randn(*s, dtype=torch.bfloat16) * 0.05)(B, H, Sk, Dh)),
        "wq": _w((lambda *s: torch.randn(*s, dtype=torch.bfloat16) * 0.8)(D, H * Dh) * (D ** -0.5)),
        "wo": _w((lambda *s: torch.randn(*s, dtype=torch.bfloat16) * 0.05)(H * Dh, D) * ((H * Dh) ** -0.5)),
    }

def reference(x, k_cache, v_cache, wq, wo):
    B, Sq, D = x.shape
    H, Dh = 32, 128
    q = (lambda x, *d: x.permute(*d))((x @ wq).reshape(B, Sq, H, Dh), 0, 2, 1, 3)
    scores = torch.einsum("bhqd,bhkd->bhqk", q, k_cache) * (Dh ** -0.5)
    p = _softmax(scores, axis=-1)
    o = torch.einsum("bhqk,bhkd->bhqd", p, v_cache)
    return (lambda x, *d: x.permute(*d))(o, 0, 2, 1, 3).reshape(B, Sq, H * Dh) @ wo
```

```asm
; @launch kernel=attn_kernel grid=(256,1,1) block=(512,1,1) lds=163840
; @launch kernel=oproj_kernel grid=(216,1,1) block=(256,1,1) lds=52224
.amdgcn_target "amdgcn-amd-amdhsa--gfx950"
.text
.globl attn_kernel
.p2align 8
.type attn_kernel,@function
attn_kernel:
    s_cmp_ge_u32 s2, 256
    s_cbranch_scc1 attn_kernel_done
    s_load_dwordx4 s[4:7], s[0:1], 0
    s_load_dwordx4 s[24:27], s[0:1], 16
    s_load_dwordx2 s[28:29], s[0:1], 56
    s_load_dwordx2 s[56:57], s[0:1], 32
    s_and_b32 s30, s2, 7
    s_lshl_b32 s30, s30, 2
    s_lshr_b32 s31, s2, 3
    s_and_b32 s31, s31, 3
    s_add_u32 s30, s30, s31
    s_lshr_b32 s31, s2, 5
    s_and_b32 s60, s31, 1
    v_and_b32 v1, 63, v0
    v_lshrrev_b32 v2, 6, v0
    s_nop 0
    v_readfirstlane_b32 s32, v2
    v_lshrrev_b32 v2, 4, v1
    v_and_b32 v3, 15, v1
    s_lshl_b32 s35, s32, 10
    s_lshl_b32 s33, s32, 2
    v_add_u32 v4, s33, v2
    s_and_b32 s33, s32, 3
    s_lshl_b32 s33, s33, 2
    v_add_u32 v7, s33, v2
    v_xor_b32 v5, v7, v3
    v_lshlrev_b32 v5, 4, v5
    v_lshlrev_b32 v6, 8, v7
    v_add_u32 v30, v6, v5
    s_and_b32 s33, s32, 1
    s_lshl_b32 s33, s33, 1
    v_lshlrev_b32 v5, 2, v2
    v_or_b32 v5, s33, v5
    v_xor_b32 v5, v5, v3
    v_lshlrev_b32 v5, 4, v5
    v_add_u32 v31, v6, v5
    s_and_b32 s44, s32, 3
    s_lshl_b32 s44, s44, 10
    s_lshr_b32 s38, s32, 2
    v_lshlrev_b32 v5, 2, v2
    v_xor_b32 v5, v5, v3
    v_lshlrev_b32 v5, 4, v5
    v_lshlrev_b32 v6, 13, v4
    v_add_u32 v101, v6, v5
    s_and_b32 s33, s32, 1
    s_lshl_b32 s33, s33, 2
    v_or_b32 v5, s33, v2
    v_and_b32 v6, 7, v1
    v_xor_b32 v5, v5, v6
    v_lshlrev_b32 v5, 4, v5
    v_lshrrev_b32 v6, 3, v1
    s_lshl_b32 s33, s32, 3
    v_add_u32 v6, s33, v6
    v_mul_u32_u24 v6, 1152, v6
    v_add_u32 v100, v6, v5
    s_and_b32 s33, s32, 1
    s_lshl_b32 s39, s33, 3
    s_add_u32 s39, s39, 128
    s_lshl_b32 s43, s32, 3
    s_sub_u32 s39, s39, s43
    s_mul_i32 s39, s39, 1152
    s_add_u32 s43, s33, 16
    s_lshl_b32 s43, s43, 10
    s_waitcnt lgkmcnt(0)
    s_mul_i32 s33, s31, 165888
    s_add_u32 s8, s4, s33
    s_addc_u32 s9, s5, 0
    s_and_b32 s9, s9, 0xffff
    s_mov_b32 s10, 165888
    s_mov_b32 s11, 0x00020000
    s_lshl_b32 s33, s31, 5
    s_add_u32 s33, s33, s30
    s_lshl_b32 s33, s33, 17
    s_add_u32 s12, s6, s33
    s_addc_u32 s13, s7, 0
    s_and_b32 s13, s13, 0xffff
    s_mov_b32 s14, 131072
    s_mov_b32 s15, 0x00020000
    s_add_u32 s16, s24, s33
    s_addc_u32 s17, s25, 0
    s_and_b32 s17, s17, 0xffff
    s_mov_b32 s18, 131072
    s_mov_b32 s19, 0x00020000
    s_lshl_b32 s33, s30, 8
    s_add_u32 s20, s26, s33
    s_addc_u32 s21, s27, 0
    s_and_b32 s21, s21, 0xffff
    s_sub_u32 s22, 4718592, s33
    s_mov_b32 s23, 0x00020000
    s_mov_b32 s36, 0
    s_add_u32 m0, s35, 114688
    s_nop 0
    buffer_load_dwordx4 v101, s[20:23], s36 offen offset:0 lds
    s_mov_b32 s36, 262144
    s_add_u32 m0, s35, 122880
    s_nop 0
    buffer_load_dwordx4 v101, s[20:23], s36 offen offset:0 lds
    s_mov_b32 s36, 0
    s_add_u32 m0, s35, 49152
    s_nop 0
    buffer_load_dwordx4 v100, s[8:11], s36 offen offset:0 lds
    s_mov_b32 s36, 73728
    s_add_u32 m0, s35, 57344
    s_nop 0
    buffer_load_dwordx4 v100, s[8:11], s36 offen offset:0 lds
    s_cmp_ge_u32 s32, 2
    s_cbranch_scc1 attn_kernel_xs1
    s_add_u32 s36, s39, 0
    s_add_u32 m0, s43, 49152
    s_nop 0
    buffer_load_dwordx4 v100, s[8:11], s36 offen offset:0 lds
attn_kernel_xs1:
    s_mov_b32 s36, 524288
    s_add_u32 m0, s35, 131072
    s_nop 0
    buffer_load_dwordx4 v101, s[20:23], s36 offen offset:0 lds
    s_mov_b32 s36, 786432
    s_add_u32 m0, s35, 139264
    s_nop 0
    buffer_load_dwordx4 v101, s[20:23], s36 offen offset:0 lds
    s_mov_b32 s36, 128
    s_add_u32 m0, s35, 67584
    s_nop 0
    buffer_load_dwordx4 v100, s[8:11], s36 offen offset:0 lds
    s_mov_b32 s36, 73856
    s_add_u32 m0, s35, 75776
    s_nop 0
    buffer_load_dwordx4 v100, s[8:11], s36 offen offset:0 lds
    s_cmp_ge_u32 s32, 2
    s_cbranch_scc1 attn_kernel_xs2
    s_add_u32 s36, s39, 128
    s_add_u32 m0, s43, 67584
    s_nop 0
    buffer_load_dwordx4 v100, s[8:11], s36 offen offset:0 lds
attn_kernel_xs2:
    s_mov_b32 s36, 1048576
    s_add_u32 m0, s35, 147456
    s_nop 0
    buffer_load_dwordx4 v101, s[20:23], s36 offen offset:0 lds
    s_mov_b32 s36, 1310720
    s_add_u32 m0, s35, 155648
    s_nop 0
    buffer_load_dwordx4 v101, s[20:23], s36 offen offset:0 lds
    s_mov_b32 s36, 256
    s_add_u32 m0, s35, 86016
    s_nop 0
    buffer_load_dwordx4 v100, s[8:11], s36 offen offset:0 lds
    s_mov_b32 s36, 73984
    s_add_u32 m0, s35, 94208
    s_nop 0
    buffer_load_dwordx4 v100, s[8:11], s36 offen offset:0 lds
    s_cmp_ge_u32 s32, 2
    s_cbranch_scc1 attn_kernel_xs3
    s_add_u32 s36, s39, 256
    s_add_u32 m0, s43, 86016
    s_nop 0
    buffer_load_dwordx4 v100, s[8:11], s36 offen offset:0 lds
attn_kernel_xs3:
    s_mov_b32 s24, s28
    s_and_b32 s25, s29, 0xffff
    s_mov_b32 s26, 9437184
    s_mov_b32 s27, 0x00020000
    s_mov_b32 s34, 0x3e0293ee
    s_and_b32 s37, s32, 3
    s_lshr_b32 s38, s32, 2
    v_and_b32 v4, 31, v1
    v_lshrrev_b32 v5, 5, v1
    s_lshl_b32 s33, s37, 5
    v_add_u32 v6, s33, v4
    v_bfe_u32 v7, v6, 1, 3
    v_xor_b32 v7, v7, v5
    v_lshlrev_b32 v7, 4, v7
    v_lshlrev_b32 v6, 7, v6
    v_add_u32 v6, v6, v7
    v_add_u32 v102, 49152, v6
    v_xor_b32 v103, 32, v102
    v_xor_b32 v104, 64, v102
    v_xor_b32 v105, 96, v102
    v_bfe_u32 v7, v3, 1, 3
    v_xor_b32 v7, v7, v2
    v_lshlrev_b32 v7, 4, v7
    v_lshlrev_b32 v6, 7, v3
    v_add_u32 v6, v6, v7
    v_add_u32 v106, 65536, v6
    v_xor_b32 v107, 64, v106
    v_bfe_u32 v6, v1, 4, 1
    v_lshlrev_b32 v6, 1, v6
    v_and_b32 v7, 1, v1
    v_or_b32 v6, v6, v7
    v_bfe_u32 v7, v1, 2, 2
    v_lshlrev_b32 v8, 2, v7
    v_xor_b32 v6, v6, v8
    v_bfe_u32 v8, v1, 1, 1
    v_lshlrev_b32 v8, 3, v8
    v_lshlrev_b32 v26, 3, v5
    v_add_u32 v26, v26, v7
    v_lshlrev_b32 v26, 8, v26
    v_lshlrev_b32 v27, 4, v6
    v_add3_u32 v26, v26, v27, v8
    v_add_u32 v26, 114688, v26
    s_lshl_b32 s33, s38, 7
    v_xor_b32 v108, s33, v26
    v_xor_b32 v109, 64, v108
    v_and_b32 v6, 3, v1
    s_lshr_b32 s33, s32, 1
    s_lshl_b32 s33, s33, 2
    v_add_u32 v26, s33, v6
    v_lshlrev_b32 v8, 2, v7
    v_xor_b32 v26, v26, v8
    v_lshlrev_b32 v26, 4, v26
    v_lshlrev_b32 v27, 3, v2
    v_add_u32 v27, v27, v7
    v_lshlrev_b32 v27, 8, v27
    s_and_b32 s33, s32, 1
    s_lshl_b32 s33, s33, 3
    s_add_u32 s33, s33, 114688
    v_add3_u32 v110, v26, v27, s33
    s_waitcnt vmcnt(8)
    s_barrier
    ds_read_b128 v[128:131], v102 offset:0
    ds_read_b64_tr_b16 v[144:145], v108 offset:0
    ds_read_b64_tr_b16 v[146:147], v108 offset:1024
    ds_read_b64_tr_b16 v[148:149], v109 offset:0
    ds_read_b64_tr_b16 v[150:151], v109 offset:1024
    ds_read_b128 v[132:135], v103 offset:0
    ds_read_b64_tr_b16 v[152:153], v108 offset:4096
    ds_read_b64_tr_b16 v[154:155], v108 offset:5120
    ds_read_b64_tr_b16 v[156:157], v109 offset:4096
    ds_read_b64_tr_b16 v[158:159], v109 offset:5120
    ds_read_b128 v[136:139], v104 offset:0
    ds_read_b64_tr_b16 v[160:161], v108 offset:8192
    ds_read_b64_tr_b16 v[162:163], v108 offset:9216
    ds_read_b64_tr_b16 v[164:165], v109 offset:8192
    ds_read_b64_tr_b16 v[166:167], v109 offset:9216
    ds_read_b128 v[140:143], v105 offset:0
    ds_read_b64_tr_b16 v[168:169], v108 offset:12288
    ds_read_b64_tr_b16 v[170:171], v108 offset:13312
    ds_read_b64_tr_b16 v[172:173], v109 offset:12288
    ds_read_b64_tr_b16 v[174:175], v109 offset:13312
    ds_read_b128 v[176:179], v106 offset:0
    ds_read_b64_tr_b16 v[184:185], v110 offset:0
    ds_read_b64_tr_b16 v[186:187], v110 offset:1024
    ds_read_b128 v[180:183], v107 offset:0
    ds_read_b64_tr_b16 v[188:189], v110 offset:8192
    ds_read_b64_tr_b16 v[190:191], v110 offset:9216
    s_waitcnt lgkmcnt(0)
    s_waitcnt vmcnt(4)
    s_barrier
    s_mov_b32 s36, 1572864
    s_add_u32 m0, s35, 114688
    s_nop 0
    buffer_load_dwordx4 v101, s[20:23], s36 offen offset:0 lds
    s_mov_b32 s36, 1835008
    s_add_u32 m0, s35, 122880
    s_nop 0
    buffer_load_dwordx4 v101, s[20:23], s36 offen offset:0 lds
    s_mov_b32 s36, 384
    s_add_u32 m0, s35, 49152
    s_nop 0
    buffer_load_dwordx4 v100, s[8:11], s36 offen offset:0 lds
    s_mov_b32 s36, 74112
    s_add_u32 m0, s35, 57344
    s_nop 0
    buffer_load_dwordx4 v100, s[8:11], s36 offen offset:0 lds
    s_cmp_ge_u32 s32, 2
    s_cbranch_scc1 attn_kernel_xs4
    s_add_u32 s36, s39, 384
    s_add_u32 m0, s43, 49152
    s_nop 0
    buffer_load_dwordx4 v100, s[8:11], s36 offen offset:0 lds
attn_kernel_xs4:
    v_mfma_f32_32x32x16_bf16 v[64:79], v[144:147], v[128:131], 0
    ds_read_b128 v[192:195], v102 offset:18432
    ds_read_b64_tr_b16 v[208:209], v108 offset:16384
    ds_read_b64_tr_b16 v[210:211], v108 offset:17408
    v_mfma_f32_32x32x16_bf16 v[80:95], v[148:151], v[128:131], 0
    ds_read_b64_tr_b16 v[212:213], v109 offset:16384
    ds_read_b64_tr_b16 v[214:215], v109 offset:17408
    ds_read_b128 v[196:199], v103 offset:18432
    v_mfma_f32_32x32x16_bf16 v[64:79], v[152:155], v[132:135], v[64:79]
    ds_read_b64_tr_b16 v[216:217], v108 offset:20480
    ds_read_b64_tr_b16 v[218:219], v108 offset:21504
    ds_read_b64_tr_b16 v[220:221], v109 offset:20480
    v_mfma_f32_32x32x16_bf16 v[80:95], v[156:159], v[132:135], v[80:95]
    ds_read_b64_tr_b16 v[222:223], v109 offset:21504
    ds_read_b128 v[200:203], v104 offset:18432
    ds_read_b64_tr_b16 v[224:225], v108 offset:24576
    v_mfma_f32_32x32x16_bf16 v[64:79], v[160:163], v[136:139], v[64:79]
    ds_read_b64_tr_b16 v[226:227], v108 offset:25600
    ds_read_b64_tr_b16 v[228:229], v109 offset:24576
    ds_read_b64_tr_b16 v[230:231], v109 offset:25600
    v_mfma_f32_32x32x16_bf16 v[80:95], v[164:167], v[136:139], v[80:95]
    ds_read_b128 v[204:207], v105 offset:18432
    ds_read_b64_tr_b16 v[232:233], v108 offset:28672
    ds_read_b64_tr_b16 v[234:235], v108 offset:29696
    v_mfma_f32_32x32x16_bf16 v[64:79], v[168:171], v[140:143], v[64:79]
    ds_read_b64_tr_b16 v[236:237], v109 offset:28672
    ds_read_b64_tr_b16 v[238:239], v109 offset:29696
    ds_read_b128 v[240:243], v106 offset:18432
    v_mfma_f32_32x32x16_bf16 v[80:95], v[172:175], v[140:143], v[80:95]
    ds_read_b64_tr_b16 v[248:249], v110 offset:16384
    ds_read_b64_tr_b16 v[250:251], v110 offset:17408
    ds_read_b128 v[244:247], v107 offset:18432
    v_mfma_f32_16x16x32_bf16 v[96:99], v[184:187], v[176:179], 0
    ds_read_b64_tr_b16 v[252:253], v110 offset:24576
    v_mfma_f32_16x16x32_bf16 v[96:99], v[188:191], v[180:183], v[96:99]
    ds_read_b64_tr_b16 v[254:255], v110 offset:25600
    s_waitcnt lgkmcnt(0)
    s_waitcnt vmcnt(4)
    s_barrier
    s_mov_b32 s36, 2097152
    s_add_u32 m0, s35, 131072
    s_nop 0
    buffer_load_dwordx4 v101, s[20:23], s36 offen offset:0 lds
    s_mov_b32 s36, 2359296
    s_add_u32 m0, s35, 139264
    s_nop 0
    buffer_load_dwordx4 v101, s[20:23], s36 offen offset:0 lds
    s_mov_b32 s36, 512
    s_add_u32 m0, s35, 67584
    s_nop 0
    buffer_load_dwordx4 v100, s[8:11], s36 offen offset:0 lds
    s_mov_b32 s36, 74240
    s_add_u32 m0, s35, 75776
    s_nop 0
    buffer_load_dwordx4 v100, s[8:11], s36 offen offset:0 lds
    s_cmp_ge_u32 s32, 2
    s_cbranch_scc1 attn_kernel_xs5
    s_add_u32 s36, s39, 512
    s_add_u32 m0, s43, 67584
    s_nop 0
    buffer_load_dwordx4 v100, s[8:11], s36 offen offset:0 lds
attn_kernel_xs5:
    v_mfma_f32_32x32x16_bf16 v[64:79], v[208:211], v[192:195], v[64:79]
    ds_read_b128 v[128:131], v102 offset:36864
    ds_read_b64_tr_b16 v[144:145], v108 offset:32768
    ds_read_b64_tr_b16 v[146:147], v108 offset:33792
    v_mfma_f32_32x32x16_bf16 v[80:95], v[212:215], v[192:195], v[80:95]
    ds_read_b64_tr_b16 v[148:149], v109 offset:32768
    ds_read_b64_tr_b16 v[150:151], v109 offset:33792
    ds_read_b128 v[132:135], v103 offset:36864
    v_mfma_f32_32x32x16_bf16 v[64:79], v[216:219], v[196:199], v[64:79]
    ds_read_b64_tr_b16 v[152:153], v108 offset:36864
    ds_read_b64_tr_b16 v[154:155], v108 offset:37888
    ds_read_b64_tr_b16 v[156:157], v109 offset:36864
    v_mfma_f32_32x32x16_bf16 v[80:95], v[220:223], v[196:199], v[80:95]
    ds_read_b64_tr_b16 v[158:159], v109 offset:37888
    ds_read_b128 v[136:139], v104 offset:36864
    ds_read_b64_tr_b16 v[160:161], v108 offset:40960
    v_mfma_f32_32x32x16_bf16 v[64:79], v[224:227], v[200:203], v[64:79]
    ds_read_b64_tr_b16 v[162:163], v108 offset:41984
    ds_read_b64_tr_b16 v[164:165], v109 offset:40960
    ds_read_b64_tr_b16 v[166:167], v109 offset:41984
    v_mfma_f32_32x32x16_bf16 v[80:95], v[228:231], v[200:203], v[80:95]
    ds_read_b128 v[140:143], v105 offset:36864
    ds_read_b64_tr_b16 v[168:169], v108 offset:45056
    ds_read_b64_tr_b16 v[170:171], v108 offset:46080
    v_mfma_f32_32x32x16_bf16 v[64:79], v[232:235], v[204:207], v[64:79]
    ds_read_b64_tr_b16 v[172:173], v109 offset:45056
    ds_read_b64_tr_b16 v[174:175], v109 offset:46080
    ds_read_b128 v[176:179], v106 offset:36864
    v_mfma_f32_32x32x16_bf16 v[80:95], v[236:239], v[204:207], v[80:95]
    ds_read_b64_tr_b16 v[184:185], v110 offset:32768
    ds_read_b64_tr_b16 v[186:187], v110 offset:33792
    ds_read_b128 v[180:183], v107 offset:36864
    v_mfma_f32_16x16x32_bf16 v[96:99], v[248:251], v[240:243], v[96:99]
    ds_read_b64_tr_b16 v[188:189], v110 offset:40960
    v_mfma_f32_16x16x32_bf16 v[96:99], v[252:255], v[244:247], v[96:99]
    ds_read_b64_tr_b16 v[190:191], v110 offset:41984
    s_waitcnt lgkmcnt(0)
    s_waitcnt vmcnt(4)
    s_barrier
    s_mov_b32 s36, 2621440
    s_add_u32 m0, s35, 147456
    s_nop 0
    buffer_load_dwordx4 v101, s[20:23], s36 offen offset:0 lds
    s_mov_b32 s36, 2883584
    s_add_u32 m0, s35, 155648
    s_nop 0
    buffer_load_dwordx4 v101, s[20:23], s36 offen offset:0 lds
    s_mov_b32 s36, 640
    s_add_u32 m0, s35, 86016
    s_nop 0
    buffer_load_dwordx4 v100, s[8:11], s36 offen offset:0 lds
    s_mov_b32 s36, 74368
    s_add_u32 m0, s35, 94208
    s_nop 0
    buffer_load_dwordx4 v100, s[8:11], s36 offen offset:0 lds
    s_cmp_ge_u32 s32, 2
    s_cbranch_scc1 attn_kernel_xs6
    s_add_u32 s36, s39, 640
    s_add_u32 m0, s43, 86016
    s_nop 0
    buffer_load_dwordx4 v100, s[8:11], s36 offen offset:0 lds
attn_kernel_xs6:
    v_mfma_f32_32x32x16_bf16 v[64:79], v[144:147], v[128:131], v[64:79]
    ds_read_b128 v[192:195], v102 offset:0
    ds_read_b64_tr_b16 v[208:209], v108 offset:0
    ds_read_b64_tr_b16 v[210:211], v108 offset:1024
    v_mfma_f32_32x32x16_bf16 v[80:95], v[148:151], v[128:131], v[80:95]
    ds_read_b64_tr_b16 v[212:213], v109 offset:0
    ds_read_b64_tr_b16 v[214:215], v109 offset:1024
    ds_read_b128 v[196:199], v103 offset:0
    v_mfma_f32_32x32x16_bf16 v[64:79], v[152:155], v[132:135], v[64:79]
    ds_read_b64_tr_b16 v[216:217], v108 offset:4096
    ds_read_b64_tr_b16 v[218:219], v108 offset:5120
    ds_read_b64_tr_b16 v[220:221], v109 offset:4096
    v_mfma_f32_32x32x16_bf16 v[80:95], v[156:159], v[132:135], v[80:95]
    ds_read_b64_tr_b16 v[222:223], v109 offset:5120
    ds_read_b128 v[200:203], v104 offset:0
    ds_read_b64_tr_b16 v[224:225], v108 offset:8192
    v_mfma_f32_32x32x16_bf16 v[64:79], v[160:163], v[136:139], v[64:79]
    ds_read_b64_tr_b16 v[226:227], v108 offset:9216
    ds_read_b64_tr_b16 v[228:229], v109 offset:8192
    ds_read_b64_tr_b16 v[230:231], v109 offset:9216
    v_mfma_f32_32x32x16_bf16 v[80:95], v[164:167], v[136:139], v[80:95]
    ds_read_b128 v[204:207], v105 offset:0
    ds_read_b64_tr_b16 v[232:233], v108 offset:12288
    ds_read_b64_tr_b16 v[234:235], v108 offset:13312
    v_mfma_f32_32x32x16_bf16 v[64:79], v[168:171], v[140:143], v[64:79]
    ds_read_b64_tr_b16 v[236:237], v109 offset:12288
    ds_read_b64_tr_b16 v[238:239], v109 offset:13312
    ds_read_b128 v[240:243], v106 offset:0
    v_mfma_f32_32x32x16_bf16 v[80:95], v[172:175], v[140:143], v[80:95]
    ds_read_b64_tr_b16 v[248:249], v110 offset:0
    ds_read_b64_tr_b16 v[250:251], v110 offset:1024
    ds_read_b128 v[244:247], v107 offset:0
    v_mfma_f32_16x16x32_bf16 v[96:99], v[184:187], v[176:179], v[96:99]
    ds_read_b64_tr_b16 v[252:253], v110 offset:8192
    v_mfma_f32_16x16x32_bf16 v[96:99], v[188:191], v[180:183], v[96:99]
    ds_read_b64_tr_b16 v[254:255], v110 offset:9216
    s_waitcnt lgkmcnt(0)
    s_waitcnt vmcnt(4)
    s_barrier
    s_mov_b32 s36, 3145728
    s_add_u32 m0, s35, 114688
    s_nop 0
    buffer_load_dwordx4 v101, s[20:23], s36 offen offset:0 lds
    s_mov_b32 s36, 3407872
    s_add_u32 m0, s35, 122880
    s_nop 0
    buffer_load_dwordx4 v101, s[20:23], s36 offen offset:0 lds
    s_mov_b32 s36, 768
    s_add_u32 m0, s35, 49152
    s_nop 0
    buffer_load_dwordx4 v100, s[8:11], s36 offen offset:0 lds
    s_mov_b32 s36, 74496
    s_add_u32 m0, s35, 57344
    s_nop 0
    buffer_load_dwordx4 v100, s[8:11], s36 offen offset:0 lds
    s_cmp_ge_u32 s32, 2
    s_cbranch_scc1 attn_kernel_xs7
    s_add_u32 s36, s39, 768
    s_add_u32 m0, s43, 49152
    s_nop 0
    buffer_load_dwordx4 v100, s[8:11], s36 offen offset:0 lds
attn_kernel_xs7:
    v_mfma_f32_32x32x16_bf16 v[64:79], v[208:211], v[192:195], v[64:79]
    ds_read_b128 v[128:131], v102 offset:18432
    ds_read_b64_tr_b16 v[144:145], v108 offset:16384
    ds_read_b64_tr_b16 v[146:147], v108 offset:17408
    v_mfma_f32_32x32x16_bf16 v[80:95], v[212:215], v[192:195], v[80:95]
    ds_read_b64_tr_b16 v[148:149], v109 offset:16384
    ds_read_b64_tr_b16 v[150:151], v109 offset:17408
    ds_read_b128 v[132:135], v103 offset:18432
    v_mfma_f32_32x32x16_bf16 v[64:79], v[216:219], v[196:199], v[64:79]
    ds_read_b64_tr_b16 v[152:153], v108 offset:20480
    ds_read_b64_tr_b16 v[154:155], v108 offset:21504
    ds_read_b64_tr_b16 v[156:157], v109 offset:20480
    v_mfma_f32_32x32x16_bf16 v[80:95], v[220:223], v[196:199], v[80:95]
    ds_read_b64_tr_b16 v[158:159], v109 offset:21504
    ds_read_b128 v[136:139], v104 offset:18432
    ds_read_b64_tr_b16 v[160:161], v108 offset:24576
    v_mfma_f32_32x32x16_bf16 v[64:79], v[224:227], v[200:203], v[64:79]
    ds_read_b64_tr_b16 v[162:163], v108 offset:25600
    ds_read_b64_tr_b16 v[164:165], v109 offset:24576
    ds_read_b64_tr_b16 v[166:167], v109 offset:25600
    v_mfma_f32_32x32x16_bf16 v[80:95], v[228:231], v[200:203], v[80:95]
    ds_read_b128 v[140:143], v105 offset:18432
    ds_read_b64_tr_b16 v[168:169], v108 offset:28672
    ds_read_b64_tr_b16 v[170:171], v108 offset:29696
    v_mfma_f32_32x32x16_bf16 v[64:79], v[232:235], v[204:207], v[64:79]
    ds_read_b64_tr_b16 v[172:173], v109 offset:28672
    ds_read_b64_tr_b16 v[174:175], v109 offset:29696
    ds_read_b128 v[176:179], v106 offset:18432
    v_mfma_f32_32x32x16_bf16 v[80:95], v[236:239], v[204:207], v[80:95]
    ds_read_b64_tr_b16 v[184:185], v110 offset:16384
    ds_read_b64_tr_b16 v[186:187], v110 offset:17408
    ds_read_b128 v[180:183], v107 offset:18432
    v_mfma_f32_16x16x32_bf16 v[96:99], v[248:251], v[240:243], v[96:99]
    ds_read_b64_tr_b16 v[188:189], v110 offset:24576
    v_mfma_f32_16x16x32_bf16 v[96:99], v[252:255], v[244:247], v[96:99]
    ds_read_b64_tr_b16 v[190:191], v110 offset:25600
    s_waitcnt lgkmcnt(0)
    s_waitcnt vmcnt(4)
    s_barrier
    s_mov_b32 s36, 3670016
    s_add_u32 m0, s35, 131072
    s_nop 0
    buffer_load_dwordx4 v101, s[20:23], s36 offen offset:0 lds
    s_mov_b32 s36, 3932160
    s_add_u32 m0, s35, 139264
    s_nop 0
    buffer_load_dwordx4 v101, s[20:23], s36 offen offset:0 lds
    s_mov_b32 s36, 896
    s_add_u32 m0, s35, 67584
    s_nop 0
    buffer_load_dwordx4 v100, s[8:11], s36 offen offset:0 lds
    s_mov_b32 s36, 74624
    s_add_u32 m0, s35, 75776
    s_nop 0
    buffer_load_dwordx4 v100, s[8:11], s36 offen offset:0 lds
    s_cmp_ge_u32 s32, 2
    s_cbranch_scc1 attn_kernel_xs8
    s_add_u32 s36, s39, 896
    s_add_u32 m0, s43, 67584
    s_nop 0
    buffer_load_dwordx4 v100, s[8:11], s36 offen offset:0 lds
attn_kernel_xs8:
    v_mfma_f32_32x32x16_bf16 v[64:79], v[144:147], v[128:131], v[64:79]
    ds_read_b128 v[192:195], v102 offset:36864
    ds_read_b64_tr_b16 v[208:209], v108 offset:32768
    ds_read_b64_tr_b16 v[210:211], v108 offset:33792
    v_mfma_f32_32x32x16_bf16 v[80:95], v[148:151], v[128:131], v[80:95]
    ds_read_b64_tr_b16 v[212:213], v109 offset:32768
    ds_read_b64_tr_b16 v[214:215], v109 offset:33792
    ds_read_b128 v[196:199], v103 offset:36864
    v_mfma_f32_32x32x16_bf16 v[64:79], v[152:155], v[132:135], v[64:79]
    ds_read_b64_tr_b16 v[216:217], v108 offset:36864
    ds_read_b64_tr_b16 v[218:219], v108 offset:37888
    ds_read_b64_tr_b16 v[220:221], v109 offset:36864
    v_mfma_f32_32x32x16_bf16 v[80:95], v[156:159], v[132:135], v[80:95]
    ds_read_b64_tr_b16 v[222:223], v109 offset:37888
    ds_read_b128 v[200:203], v104 offset:36864
    ds_read_b64_tr_b16 v[224:225], v108 offset:40960
    v_mfma_f32_32x32x16_bf16 v[64:79], v[160:163], v[136:139], v[64:79]
    ds_read_b64_tr_b16 v[226:227], v108 offset:41984
    ds_read_b64_tr_b16 v[228:229], v109 offset:40960
    ds_read_b64_tr_b16 v[230:231], v109 offset:41984
    v_mfma_f32_32x32x16_bf16 v[80:95], v[164:167], v[136:139], v[80:95]
    ds_read_b128 v[204:207], v105 offset:36864
    ds_read_b64_tr_b16 v[232:233], v108 offset:45056
    ds_read_b64_tr_b16 v[234:235], v108 offset:46080
    v_mfma_f32_32x32x16_bf16 v[64:79], v[168:171], v[140:143], v[64:79]
    ds_read_b64_tr_b16 v[236:237], v109 offset:45056
    ds_read_b64_tr_b16 v[238:239], v109 offset:46080
    ds_read_b128 v[240:243], v106 offset:36864
    v_mfma_f32_32x32x16_bf16 v[80:95], v[172:175], v[140:143], v[80:95]
    ds_read_b64_tr_b16 v[248:249], v110 offset:32768
    ds_read_b64_tr_b16 v[250:251], v110 offset:33792
    ds_read_b128 v[244:247], v107 offset:36864
    v_mfma_f32_16x16x32_bf16 v[96:99], v[184:187], v[176:179], v[96:99]
    ds_read_b64_tr_b16 v[252:253], v110 offset:40960
    v_mfma_f32_16x16x32_bf16 v[96:99], v[188:191], v[180:183], v[96:99]
    ds_read_b64_tr_b16 v[254:255], v110 offset:41984
    s_waitcnt lgkmcnt(0)
    s_waitcnt vmcnt(4)
    s_barrier
    s_mov_b32 s36, 4194304
    s_add_u32 m0, s35, 147456
    s_nop 0
    buffer_load_dwordx4 v101, s[20:23], s36 offen offset:0 lds
    s_mov_b32 s36, 4456448
    s_add_u32 m0, s35, 155648
    s_nop 0
    buffer_load_dwordx4 v101, s[20:23], s36 offen offset:0 lds
    s_mov_b32 s36, 1024
    s_add_u32 m0, s35, 86016
    s_nop 0
    buffer_load_dwordx4 v100, s[8:11], s36 offen offset:0 lds
    s_mov_b32 s36, 74752
    s_add_u32 m0, s35, 94208
    s_nop 0
    buffer_load_dwordx4 v100, s[8:11], s36 offen offset:0 lds
    s_cmp_ge_u32 s32, 2
    s_cbranch_scc1 attn_kernel_xs9
    s_add_u32 s36, s39, 1024
    s_add_u32 m0, s43, 86016
    s_nop 0
    buffer_load_dwordx4 v100, s[8:11], s36 offen offset:0 lds
attn_kernel_xs9:
    v_mfma_f32_32x32x16_bf16 v[64:79], v[208:211], v[192:195], v[64:79]
    ds_read_b128 v[128:131], v102 offset:0
    ds_read_b64_tr_b16 v[144:145], v108 offset:0
    ds_read_b64_tr_b16 v[146:147], v108 offset:1024
    v_mfma_f32_32x32x16_bf16 v[80:95], v[212:215], v[192:195], v[80:95]
    ds_read_b64_tr_b16 v[148:149], v109 offset:0
    ds_read_b64_tr_b16 v[150:151], v109 offset:1024
    ds_read_b128 v[132:135], v103 offset:0
    v_mfma_f32_32x32x16_bf16 v[64:79], v[216:219], v[196:199], v[64:79]
    ds_read_b64_tr_b16 v[152:153], v108 offset:4096
    ds_read_b64_tr_b16 v[154:155], v108 offset:5120
    ds_read_b64_tr_b16 v[156:157], v109 offset:4096
    v_mfma_f32_32x32x16_bf16 v[80:95], v[220:223], v[196:199], v[80:95]
    ds_read_b64_tr_b16 v[158:159], v109 offset:5120
    ds_read_b128 v[136:139], v104 offset:0
    ds_read_b64_tr_b16 v[160:161], v108 offset:8192
    v_mfma_f32_32x32x16_bf16 v[64:79], v[224:227], v[200:203], v[64:79]
    ds_read_b64_tr_b16 v[162:163], v108 offset:9216
    ds_read_b64_tr_b16 v[164:165], v109 offset:8192
    ds_read_b64_tr_b16 v[166:167], v109 offset:9216
    v_mfma_f32_32x32x16_bf16 v[80:95], v[228:231], v[200:203], v[80:95]
    ds_read_b128 v[140:143], v105 offset:0
    ds_read_b64_tr_b16 v[168:169], v108 offset:12288
    ds_read_b64_tr_b16 v[170:171], v108 offset:13312
    v_mfma_f32_32x32x16_bf16 v[64:79], v[232:235], v[204:207], v[64:79]
    ds_read_b64_tr_b16 v[172:173], v109 offset:12288
    ds_read_b64_tr_b16 v[174:175], v109 offset:13312
    ds_read_b128 v[176:179], v106 offset:0
    v_mfma_f32_32x32x16_bf16 v[80:95], v[236:239], v[204:207], v[80:95]
    ds_read_b64_tr_b16 v[184:185], v110 offset:0
    ds_read_b64_tr_b16 v[186:187], v110 offset:1024
    ds_read_b128 v[180:183], v107 offset:0
    v_mfma_f32_16x16x32_bf16 v[96:99], v[248:251], v[240:243], v[96:99]
    ds_read_b64_tr_b16 v[188:189], v110 offset:8192
    v_mfma_f32_16x16x32_bf16 v[96:99], v[252:255], v[244:247], v[96:99]
    ds_read_b64_tr_b16 v[190:191], v110 offset:9216
    s_cmp_eq_u32 s38, 0
    s_cbranch_scc1 attn_kernel_dl10
    s_mov_b32 s36, 0
    s_add_u32 m0, s44, 0
    s_nop 0
    buffer_load_dwordx4 v30, s[12:15], s36 offen offset:0 nt lds
    s_mov_b32 s36, 4096
    s_add_u32 m0, s44, 4096
    s_nop 0
    buffer_load_dwordx4 v30, s[12:15], s36 offen offset:0 nt lds
    s_mov_b32 s36, 8192
    s_add_u32 m0, s44, 8192
    s_nop 0
    buffer_load_dwordx4 v30, s[12:15], s36 offen offset:0 nt lds
    s_mov_b32 s36, 12288
    s_add_u32 m0, s44, 12288
    s_nop 0
    buffer_load_dwordx4 v30, s[12:15], s36 offen offset:0 nt lds
attn_kernel_dl10:
    s_waitcnt lgkmcnt(0)
    s_cmp_eq_u32 s38, 0
    s_cbranch_scc1 attn_kernel_wa11
    s_waitcnt vmcnt(8)
    s_branch attn_kernel_wb12
attn_kernel_wa11:
    s_waitcnt vmcnt(4)
attn_kernel_wb12:
    s_barrier
    v_mfma_f32_32x32x16_bf16 v[64:79], v[144:147], v[128:131], v[64:79]
    ds_read_b128 v[192:195], v102 offset:18432
    ds_read_b64_tr_b16 v[208:209], v108 offset:16384
    ds_read_b64_tr_b16 v[210:211], v108 offset:17408
    v_mfma_f32_32x32x16_bf16 v[80:95], v[148:151], v[128:131], v[80:95]
    ds_read_b64_tr_b16 v[212:213], v109 offset:16384
    ds_read_b64_tr_b16 v[214:215], v109 offset:17408
    ds_read_b128 v[196:199], v103 offset:18432
    v_mfma_f32_32x32x16_bf16 v[64:79], v[152:155], v[132:135], v[64:79]
    ds_read_b64_tr_b16 v[216:217], v108 offset:20480
    ds_read_b64_tr_b16 v[218:219], v108 offset:21504
    ds_read_b64_tr_b16 v[220:221], v109 offset:20480
    v_mfma_f32_32x32x16_bf16 v[80:95], v[156:159], v[132:135], v[80:95]
    ds_read_b64_tr_b16 v[222:223], v109 offset:21504
    ds_read_b128 v[200:203], v104 offset:18432
    ds_read_b64_tr_b16 v[224:225], v108 offset:24576
    v_mfma_f32_32x32x16_bf16 v[64:79], v[160:163], v[136:139], v[64:79]
    ds_read_b64_tr_b16 v[226:227], v108 offset:25600
    ds_read_b64_tr_b16 v[228:229], v109 offset:24576
    ds_read_b64_tr_b16 v[230:231], v109 offset:25600
    v_mfma_f32_32x32x16_bf16 v[80:95], v[164:167], v[136:139], v[80:95]
    ds_read_b128 v[204:207], v105 offset:18432
    ds_read_b64_tr_b16 v[232:233], v108 offset:28672
    ds_read_b64_tr_b16 v[234:235], v108 offset:29696
    v_mfma_f32_32x32x16_bf16 v[64:79], v[168:171], v[140:143], v[64:79]
    ds_read_b64_tr_b16 v[236:237], v109 offset:28672
    ds_read_b64_tr_b16 v[238:239], v109 offset:29696
    ds_read_b128 v[240:243], v106 offset:18432
    v_mfma_f32_32x32x16_bf16 v[80:95], v[172:175], v[140:143], v[80:95]
    ds_read_b64_tr_b16 v[248:249], v110 offset:16384
    ds_read_b64_tr_b16 v[250:251], v110 offset:17408
    ds_read_b128 v[244:247], v107 offset:18432
    v_mfma_f32_16x16x32_bf16 v[96:99], v[184:187], v[176:179], v[96:99]
    ds_read_b64_tr_b16 v[252:253], v110 offset:24576
    v_mfma_f32_16x16x32_bf16 v[96:99], v[188:191], v[180:183], v[96:99]
    ds_read_b64_tr_b16 v[254:255], v110 offset:25600
    s_cmp_eq_u32 s38, 0
    s_cbranch_scc1 attn_kernel_dl13
    s_mov_b32 s36, 16384
    s_add_u32 m0, s44, 16384
    s_nop 0
    buffer_load_dwordx4 v30, s[12:15], s36 offen offset:0 nt lds
    s_mov_b32 s36, 20480
    s_add_u32 m0, s44, 20480
    s_nop 0
    buffer_load_dwordx4 v30, s[12:15], s36 offen offset:0 nt lds
    s_mov_b32 s36, 24576
    s_add_u32 m0, s44, 24576
    s_nop 0
    buffer_load_dwordx4 v30, s[12:15], s36 offen offset:0 nt lds
    s_mov_b32 s36, 28672
    s_add_u32 m0, s44, 28672
    s_nop 0
    buffer_load_dwordx4 v30, s[12:15], s36 offen offset:0 nt lds
attn_kernel_dl13:
    s_waitcnt lgkmcnt(0)
    s_cmp_eq_u32 s38, 0
    s_cbranch_scc1 attn_kernel_wa14
    s_waitcnt vmcnt(8)
    s_branch attn_kernel_wb15
attn_kernel_wa14:
    s_waitcnt vmcnt(0)
attn_kernel_wb15:
    s_barrier
    v_mfma_f32_32x32x16_bf16 v[64:79], v[208:211], v[192:195], v[64:79]
    ds_read_b128 v[128:131], v102 offset:36864
    ds_read_b64_tr_b16 v[144:145], v108 offset:32768
    ds_read_b64_tr_b16 v[146:147], v108 offset:33792
    v_mfma_f32_32x32x16_bf16 v[80:95], v[212:215], v[192:195], v[80:95]
    ds_read_b64_tr_b16 v[148:149], v109 offset:32768
    ds_read_b64_tr_b16 v[150:151], v109 offset:33792
    ds_read_b128 v[132:135], v103 offset:36864
    v_mfma_f32_32x32x16_bf16 v[64:79], v[216:219], v[196:199], v[64:79]
    ds_read_b64_tr_b16 v[152:153], v108 offset:36864
    ds_read_b64_tr_b16 v[154:155], v108 offset:37888
    ds_read_b64_tr_b16 v[156:157], v109 offset:36864
    v_mfma_f32_32x32x16_bf16 v[80:95], v[220:223], v[196:199], v[80:95]
    ds_read_b64_tr_b16 v[158:159], v109 offset:37888
    ds_read_b128 v[136:139], v104 offset:36864
    ds_read_b64_tr_b16 v[160:161], v108 offset:40960
    v_mfma_f32_32x32x16_bf16 v[64:79], v[224:227], v[200:203], v[64:79]
    ds_read_b64_tr_b16 v[162:163], v108 offset:41984
    ds_read_b64_tr_b16 v[164:165], v109 offset:40960
    ds_read_b64_tr_b16 v[166:167], v109 offset:41984
    v_mfma_f32_32x32x16_bf16 v[80:95], v[228:231], v[200:203], v[80:95]
    ds_read_b128 v[140:143], v105 offset:36864
    ds_read_b64_tr_b16 v[168:169], v108 offset:45056
    ds_read_b64_tr_b16 v[170:171], v108 offset:46080
    v_mfma_f32_32x32x16_bf16 v[64:79], v[232:235], v[204:207], v[64:79]
    ds_read_b64_tr_b16 v[172:173], v109 offset:45056
    ds_read_b64_tr_b16 v[174:175], v109 offset:46080
    ds_read_b128 v[176:179], v106 offset:36864
    v_mfma_f32_32x32x16_bf16 v[80:95], v[236:239], v[204:207], v[80:95]
    ds_read_b64_tr_b16 v[184:185], v110 offset:32768
    ds_read_b64_tr_b16 v[186:187], v110 offset:33792
    ds_read_b128 v[180:183], v107 offset:36864
    v_mfma_f32_16x16x32_bf16 v[96:99], v[248:251], v[240:243], v[96:99]
    ds_read_b64_tr_b16 v[188:189], v110 offset:40960
    v_mfma_f32_16x16x32_bf16 v[96:99], v[252:255], v[244:247], v[96:99]
    ds_read_b64_tr_b16 v[190:191], v110 offset:41984
    s_cmp_eq_u32 s38, 0
    s_cbranch_scc1 attn_kernel_dl16
    s_mov_b32 s36, 0
    s_add_u32 m0, s44, 32768
    s_nop 0
    buffer_load_dwordx4 v31, s[16:19], s36 offen offset:0 nt lds
    s_mov_b32 s36, 4096
    s_add_u32 m0, s44, 36864
    s_nop 0
    buffer_load_dwordx4 v31, s[16:19], s36 offen offset:0 nt lds
    s_mov_b32 s36, 8192
    s_add_u32 m0, s44, 40960
    s_nop 0
    buffer_load_dwordx4 v31, s[16:19], s36 offen offset:0 nt lds
    s_mov_b32 s36, 12288
    s_add_u32 m0, s44, 45056
    s_nop 0
    buffer_load_dwordx4 v31, s[16:19], s36 offen offset:0 nt lds
attn_kernel_dl16:
    s_waitcnt lgkmcnt(0)
    s_barrier
    v_mfma_f32_32x32x16_bf16 v[64:79], v[144:147], v[128:131], v[64:79]
    v_mfma_f32_32x32x16_bf16 v[80:95], v[148:151], v[128:131], v[80:95]
    v_mfma_f32_32x32x16_bf16 v[64:79], v[152:155], v[132:135], v[64:79]
    v_mfma_f32_32x32x16_bf16 v[80:95], v[156:159], v[132:135], v[80:95]
    v_mfma_f32_32x32x16_bf16 v[64:79], v[160:163], v[136:139], v[64:79]
    v_mfma_f32_32x32x16_bf16 v[80:95], v[164:167], v[136:139], v[80:95]
    v_mfma_f32_32x32x16_bf16 v[64:79], v[168:171], v[140:143], v[64:79]
    v_mfma_f32_32x32x16_bf16 v[80:95], v[172:175], v[140:143], v[80:95]
    v_mfma_f32_16x16x32_bf16 v[96:99], v[184:187], v[176:179], v[96:99]
    v_mfma_f32_16x16x32_bf16 v[96:99], v[188:191], v[180:183], v[96:99]
    s_cmp_eq_u32 s38, 0
    s_cbranch_scc1 attn_kernel_dl17
    s_mov_b32 s36, 32768
    s_add_u32 m0, s44, 49152
    s_nop 0
    buffer_load_dwordx4 v30, s[12:15], s36 offen offset:0 nt lds
    s_mov_b32 s36, 36864
    s_add_u32 m0, s44, 53248
    s_nop 0
    buffer_load_dwordx4 v30, s[12:15], s36 offen offset:0 nt lds
    s_mov_b32 s36, 40960
    s_add_u32 m0, s44, 57344
    s_nop 0
    buffer_load_dwordx4 v30, s[12:15], s36 offen offset:0 nt lds
    s_mov_b32 s36, 45056
    s_add_u32 m0, s44, 61440
    s_nop 0
    buffer_load_dwordx4 v30, s[12:15], s36 offen offset:0 nt lds
attn_kernel_dl17:
    v_and_b32 v4, 31, v1
    v_lshrrev_b32 v5, 5, v1
    v_and_b32 v6, 15, v4
    v_xor_b32 v6, v6, v5
    v_lshlrev_b32 v6, 4, v6
    v_lshlrev_b32 v2, 8, v4
    v_add_u32 v28, v6, v2
    v_bfe_u32 v6, v1, 4, 1
    v_lshlrev_b32 v6, 1, v6
    v_and_b32 v2, 1, v1
    v_or_b32 v6, v6, v2
    v_bfe_u32 v2, v1, 2, 2
    v_lshlrev_b32 v3, 2, v2
    v_xor_b32 v6, v6, v3
    v_lshlrev_b32 v3, 1, v5
    v_xor_b32 v6, v6, v3
    v_lshlrev_b32 v6, 4, v6
    v_lshlrev_b32 v3, 2, v5
    v_add_u32 v3, v3, v2
    v_lshlrev_b32 v3, 8, v3
    v_bfe_u32 v2, v1, 1, 1
    v_lshlrev_b32 v2, 3, v2
    v_add3_u32 v29, v3, v6, v2
    v_cvt_pk_bf16_f32 v192, v64, v65
    v_cvt_pk_bf16_f32 v193, v66, v67
    v_cvt_pk_bf16_f32 v194, v68, v69
    v_cvt_pk_bf16_f32 v195, v70, v71
    v_cvt_pk_bf16_f32 v196, v72, v73
    v_cvt_pk_bf16_f32 v197, v74, v75
    v_cvt_pk_bf16_f32 v198, v76, v77
    v_cvt_pk_bf16_f32 v199, v78, v79
    v_cvt_pk_bf16_f32 v200, v80, v81
    v_cvt_pk_bf16_f32 v201, v82, v83
    v_cvt_pk_bf16_f32 v202, v84, v85
    v_cvt_pk_bf16_f32 v203, v86, v87
    v_cvt_pk_bf16_f32 v204, v88, v89
    v_cvt_pk_bf16_f32 v205, v90, v91
    v_cvt_pk_bf16_f32 v206, v92, v93
    v_cvt_pk_bf16_f32 v207, v94, v95
    v_cvt_pk_bf16_f32 v208, v96, v97
    v_cvt_pk_bf16_f32 v209, v98, v99
    v_lshlrev_b32 v8, 4, v1
    s_lshl_b32 s33, s37, 13
    s_add_u32 s33, s33, 131072
    v_add_u32 v7, s33, v8
    s_lshl_b32 s33, s38, 12
    v_add_u32 v4, s33, v7
    ds_write_b128 v4, v[192:195] offset:0
    ds_write_b128 v4, v[196:199] offset:1024
    ds_write_b128 v4, v[200:203] offset:2048
    ds_write_b128 v4, v[204:207] offset:3072
    s_lshr_b32 s33, s32, 1
    s_lshl_b32 s33, s33, 10
    s_and_b32 s36, s32, 1
    s_lshl_b32 s36, s36, 3
    s_add_u32 s33, s33, s36
    s_add_u32 s33, s33, 114688
    v_add_u32 v5, s33, v8
    ds_write_b64 v5, v[208:209] offset:0
    s_mov_b32 s61, 0x427af233
    s_waitcnt lgkmcnt(0)
    s_barrier
    s_cmp_eq_u32 s38, 1
    s_cbranch_scc1 attn_kernel_AUX18
    ds_read_b128 v[32:35], v7 offset:0
    ds_read_b128 v[36:39], v7 offset:1024
    ds_read_b128 v[40:43], v7 offset:2048
    ds_read_b128 v[44:47], v7 offset:3072
    ds_read_b128 v[48:51], v7 offset:4096
    ds_read_b128 v[52:55], v7 offset:5120
    ds_read_b128 v[56:59], v7 offset:6144
    ds_read_b128 v[60:63], v7 offset:7168
    s_waitcnt lgkmcnt(0)
    s_barrier
    v_add_u32 v10, 0, v28
    v_xor_b32 v11, 32, v10
    v_xor_b32 v12, 64, v10
    v_xor_b32 v13, 96, v10
    v_xor_b32 v14, 128, v10
    v_xor_b32 v15, 160, v10
    v_xor_b32 v16, 192, v10
    v_xor_b32 v17, 224, v10
    ds_read_b128 v[192:195], v10 offset:0
    ds_read_b128 v[196:199], v11 offset:0
    ds_read_b128 v[200:203], v12 offset:0
    ds_read_b128 v[204:207], v13 offset:0
    ds_read_b128 v[208:211], v14 offset:0
    ds_read_b128 v[212:215], v15 offset:0
    s_waitcnt lgkmcnt(4)
    v_mfma_f32_32x32x16_bf16 v[128:143], v[192:195], v[32:35], 0
    ds_read_b128 v[192:195], v16 offset:0
    v_mfma_f32_32x32x16_bf16 v[128:143], v[196:199], v[36:39], v[128:143]
    ds_read_b128 v[196:199], v17 offset:0
    s_waitcnt lgkmcnt(4)
    v_mfma_f32_32x32x16_bf16 v[128:143], v[200:203], v[40:43], v[128:143]
    ds_read_b128 v[200:203], v10 offset:8192
    v_mfma_f32_32x32x16_bf16 v[128:143], v[204:207], v[44:47], v[128:143]
    ds_read_b128 v[204:207], v11 offset:8192
    s_waitcnt lgkmcnt(4)
    v_mfma_f32_32x32x16_bf16 v[128:143], v[208:211], v[48:51], v[128:143]
    ds_read_b128 v[208:211], v12 offset:8192
    v_mfma_f32_32x32x16_bf16 v[128:143], v[212:215], v[52:55], v[128:143]
    ds_read_b128 v[212:215], v13 offset:8192
    s_waitcnt lgkmcnt(4)
    v_mfma_f32_32x32x16_bf16 v[128:143], v[192:195], v[56:59], v[128:143]
    ds_read_b128 v[192:195], v14 offset:8192
    v_mfma_f32_32x32x16_bf16 v[128:143], v[196:199], v[60:63], v[128:143]
    ds_read_b128 v[196:199], v15 offset:8192
    s_waitcnt lgkmcnt(4)
    v_mfma_f32_32x32x16_bf16 v[144:159], v[200:203], v[32:35], 0
    ds_read_b128 v[200:203], v16 offset:8192
    v_mfma_f32_32x32x16_bf16 v[144:159], v[204:207], v[36:39], v[144:159]
    ds_read_b128 v[204:207], v17 offset:8192
    s_waitcnt lgkmcnt(4)
    v_mfma_f32_32x32x16_bf16 v[144:159], v[208:211], v[40:43], v[144:159]
    v_mfma_f32_32x32x16_bf16 v[144:159], v[212:215], v[44:47], v[144:159]
    s_waitcnt lgkmcnt(2)
    v_mfma_f32_32x32x16_bf16 v[144:159], v[192:195], v[48:51], v[144:159]
    v_mfma_f32_32x32x16_bf16 v[144:159], v[196:199], v[52:55], v[144:159]
    s_waitcnt lgkmcnt(0)
    v_mfma_f32_32x32x16_bf16 v[144:159], v[200:203], v[56:59], v[144:159]
    v_mfma_f32_32x32x16_bf16 v[144:159], v[204:207], v[60:63], v[144:159]
    s_barrier
    v_add_u32 v10, 16384, v28
    v_xor_b32 v11, 32, v10
    v_xor_b32 v12, 64, v10
    v_xor_b32 v13, 96, v10
    v_xor_b32 v14, 128, v10
    v_xor_b32 v15, 160, v10
    v_xor_b32 v16, 192, v10
    v_xor_b32 v17, 224, v10
    ds_read_b128 v[192:195], v10 offset:0
    ds_read_b128 v[196:199], v11 offset:0
    ds_read_b128 v[200:203], v12 offset:0
    ds_read_b128 v[204:207], v13 offset:0
    ds_read_b128 v[208:211], v14 offset:0
    ds_read_b128 v[212:215], v15 offset:0
    v_add_u32 v18, 32768, v29
    v_xor_b32 v19, 64, v18
    v_xor_b32 v20, 128, v18
    v_xor_b32 v21, 192, v18
    v_max3_f32 v26, v128, v129, v130
    v_max3_f32 v27, v144, v145, v146
    v_max3_f32 v26, v26, v131, v132
    v_max3_f32 v27, v27, v147, v148
    v_max3_f32 v26, v26, v133, v134
    v_max3_f32 v27, v27, v149, v150
    v_max3_f32 v26, v26, v135, v136
    v_max3_f32 v27, v27, v151, v152
    v_max3_f32 v26, v26, v137, v138
    v_max3_f32 v27, v27, v153, v154
    v_max3_f32 v26, v26, v139, v140
    v_max3_f32 v27, v27, v155, v156
    v_max3_f32 v26, v26, v141, v142
    v_max3_f32 v27, v27, v157, v158
    v_max_f32 v26, v26, v143
    v_max_f32 v27, v27, v159
    s_waitcnt lgkmcnt(4)
    v_mfma_f32_32x32x16_bf16 v[160:175], v[192:195], v[32:35], 0
    ds_read_b128 v[192:195], v16 offset:0
    v_max_f32 v26, v26, v27
    v_mov_b32 v27, v26
    s_nop 1
    v_permlane32_swap_b32 v26, v27
    v_mfma_f32_32x32x16_bf16 v[160:175], v[196:199], v[36:39], v[160:175]
    ds_read_b128 v[196:199], v17 offset:0
    v_max_f32 v22, v26, v27
    v_mul_f32 v24, s34, v22
    v_fma_f32 v128, v128, s34, -v24
    v_fma_f32 v129, v129, s34, -v24
    s_waitcnt lgkmcnt(4)
    v_mfma_f32_32x32x16_bf16 v[160:175], v[200:203], v[40:43], v[160:175]
    ds_read_b128 v[200:203], v10 offset:8192
    v_fma_f32 v130, v130, s34, -v24
    v_fma_f32 v131, v131, s34, -v24
    v_fma_f32 v132, v132, s34, -v24
    v_fma_f32 v133, v133, s34, -v24
    v_mfma_f32_32x32x16_bf16 v[160:175], v[204:207], v[44:47], v[160:175]
    ds_read_b128 v[204:207], v11 offset:8192
    v_fma_f32 v134, v134, s34, -v24
    v_fma_f32 v135, v135, s34, -v24
    v_exp_f32 v128, v128
    v_exp_f32 v129, v129
    s_waitcnt lgkmcnt(4)
    v_mfma_f32_32x32x16_bf16 v[160:175], v[208:211], v[48:51], v[160:175]
    ds_read_b128 v[208:211], v12 offset:8192
    v_exp_f32 v130, v130
    v_exp_f32 v131, v131
    v_exp_f32 v132, v132
    v_exp_f32 v133, v133
    v_mfma_f32_32x32x16_bf16 v[160:175], v[212:215], v[52:55], v[160:175]
    ds_read_b128 v[212:215], v13 offset:8192
    v_exp_f32 v134, v134
    v_exp_f32 v135, v135
    v_mov_b32 v23, v128
    s_waitcnt lgkmcnt(4)
    v_mfma_f32_32x32x16_bf16 v[160:175], v[192:195], v[56:59], v[160:175]
    ds_read_b128 v[192:195], v14 offset:8192
    v_mov_b32 v9, v129
    v_add_f32 v23, v23, v130
    v_add_f32 v9, v9, v131
    v_add_f32 v23, v23, v132
    v_mfma_f32_32x32x16_bf16 v[160:175], v[196:199], v[60:63], v[160:175]
    ds_read_b128 v[196:199], v15 offset:8192
    v_add_f32 v9, v9, v133
    v_add_f32 v23, v23, v134
    v_add_f32 v9, v9, v135
    v_cvt_pk_bf16_f32 v128, v128, v129
    s_waitcnt lgkmcnt(4)
    v_mfma_f32_32x32x16_bf16 v[176:191], v[200:203], v[32:35], 0
    ds_read_b128 v[200:203], v16 offset:8192
    v_cvt_pk_bf16_f32 v129, v130, v131
    v_cvt_pk_bf16_f32 v130, v132, v133
    v_cvt_pk_bf16_f32 v131, v134, v135
    v_fma_f32 v136, v136, s34, -v24
    v_mfma_f32_32x32x16_bf16 v[176:191], v[204:207], v[36:39], v[176:191]
    ds_read_b128 v[204:207], v17 offset:8192
    v_fma_f32 v137, v137, s34, -v24
    v_fma_f32 v138, v138, s34, -v24
    v_fma_f32 v139, v139, s34, -v24
    v_fma_f32 v140, v140, s34, -v24
    s_waitcnt lgkmcnt(4)
    v_mfma_f32_32x32x16_bf16 v[176:191], v[208:211], v[40:43], v[176:191]
    ds_read_b64_tr_b16 v[216:217], v18 offset:0
    ds_read_b64_tr_b16 v[218:219], v18 offset:2048
    v_fma_f32 v141, v141, s34, -v24
    v_fma_f32 v142, v142, s34, -v24
    v_fma_f32 v143, v143, s34, -v24
    v_mfma_f32_32x32x16_bf16 v[176:191], v[212:215], v[44:47], v[176:191]
    ds_read_b64_tr_b16 v[220:221], v19 offset:0
    ds_read_b64_tr_b16 v[222:223], v19 offset:2048
    v_exp_f32 v136, v136
    v_exp_f32 v137, v137
    v_exp_f32 v138, v138
    v_exp_f32 v139, v139
    s_waitcnt lgkmcnt(6)
    v_mfma_f32_32x32x16_bf16 v[176:191], v[192:195], v[48:51], v[176:191]
    ds_read_b64_tr_b16 v[224:225], v20 offset:0
    ds_read_b64_tr_b16 v[226:227], v20 offset:2048
    v_exp_f32 v140, v140
    v_exp_f32 v141, v141
    v_exp_f32 v142, v142
    v_exp_f32 v143, v143
    v_mfma_f32_32x32x16_bf16 v[176:191], v[196:199], v[52:55], v[176:191]
    ds_read_b64_tr_b16 v[228:229], v21 offset:0
    ds_read_b64_tr_b16 v[230:231], v21 offset:2048
    v_add_f32 v23, v23, v136
    v_add_f32 v9, v9, v137
    v_add_f32 v23, v23, v138
    v_add_f32 v9, v9, v139
    s_waitcnt lgkmcnt(8)
    v_mfma_f32_32x32x16_bf16 v[176:191], v[200:203], v[56:59], v[176:191]
    ds_read_b64_tr_b16 v[232:233], v18 offset:4096
    ds_read_b64_tr_b16 v[234:235], v18 offset:6144
    v_add_f32 v23, v23, v140
    v_add_f32 v9, v9, v141
    v_add_f32 v23, v23, v142
    v_add_f32 v9, v9, v143
    v_mfma_f32_32x32x16_bf16 v[176:191], v[204:207], v[60:63], v[176:191]
    ds_read_b64_tr_b16 v[236:237], v19 offset:4096
    ds_read_b64_tr_b16 v[238:239], v19 offset:6144
    v_cvt_pk_bf16_f32 v136, v136, v137
    v_cvt_pk_bf16_f32 v137, v138, v139
    v_cvt_pk_bf16_f32 v138, v140, v141
    v_cvt_pk_bf16_f32 v139, v142, v143
    s_waitcnt lgkmcnt(8)
    v_mfma_f32_32x32x16_bf16 v[64:79], v[216:219], v[128:131], 0
    ds_read_b64_tr_b16 v[216:217], v20 offset:4096
    ds_read_b64_tr_b16 v[218:219], v20 offset:6144
    v_fma_f32 v144, v144, s34, -v24
    v_fma_f32 v145, v145, s34, -v24
    v_fma_f32 v146, v146, s34, -v24
    v_fma_f32 v147, v147, s34, -v24
    v_fma_f32 v148, v148, s34, -v24
    v_mfma_f32_32x32x16_bf16 v[80:95], v[220:223], v[128:131], 0
    ds_read_b64_tr_b16 v[220:221], v21 offset:4096
    ds_read_b64_tr_b16 v[222:223], v21 offset:6144
    v_fma_f32 v149, v149, s34, -v24
    v_fma_f32 v150, v150, s34, -v24
    v_fma_f32 v151, v151, s34, -v24
    v_exp_f32 v144, v144
    v_exp_f32 v145, v145
    s_waitcnt lgkmcnt(8)
    v_mfma_f32_32x32x16_bf16 v[96:111], v[224:227], v[128:131], 0
    ds_read_b64_tr_b16 v[224:225], v18 offset:8192
    ds_read_b64_tr_b16 v[226:227], v18 offset:10240
    v_exp_f32 v146, v146
    v_exp_f32 v147, v147
    v_exp_f32 v148, v148
    v_exp_f32 v149, v149
    v_exp_f32 v150, v150
    v_mfma_f32_32x32x16_bf16 v[112:127], v[228:231], v[128:131], 0
    ds_read_b64_tr_b16 v[228:229], v19 offset:8192
    ds_read_b64_tr_b16 v[230:231], v19 offset:10240
    v_exp_f32 v151, v151
    v_add_f32 v23, v23, v144
    v_add_f32 v9, v9, v145
    v_add_f32 v23, v23, v146
    v_add_f32 v9, v9, v147
    s_waitcnt lgkmcnt(8)
    v_mfma_f32_32x32x16_bf16 v[64:79], v[232:235], v[136:139], v[64:79]
    ds_read_b64_tr_b16 v[232:233], v20 offset:8192
    ds_read_b64_tr_b16 v[234:235], v20 offset:10240
    v_add_f32 v23, v23, v148
    v_add_f32 v9, v9, v149
    v_add_f32 v23, v23, v150
    v_add_f32 v9, v9, v151
    v_cvt_pk_bf16_f32 v144, v144, v145
    v_mfma_f32_32x32x16_bf16 v[80:95], v[236:239], v[136:139], v[80:95]
    ds_read_b64_tr_b16 v[236:237], v21 offset:8192
    ds_read_b64_tr_b16 v[238:239], v21 offset:10240
    v_cvt_pk_bf16_f32 v145, v146, v147
    v_cvt_pk_bf16_f32 v146, v148, v149
    v_cvt_pk_bf16_f32 v147, v150, v151
    v_fma_f32 v152, v152, s34, -v24
    v_fma_f32 v153, v153, s34, -v24
    s_waitcnt lgkmcnt(8)
    v_mfma_f32_32x32x16_bf16 v[96:111], v[216:219], v[136:139], v[96:111]
    ds_read_b64_tr_b16 v[216:217], v18 offset:12288
    ds_read_b64_tr_b16 v[218:219], v18 offset:14336
    v_fma_f32 v154, v154, s34, -v24
    v_fma_f32 v155, v155, s34, -v24
    v_fma_f32 v156, v156, s34, -v24
    v_fma_f32 v157, v157, s34, -v24
    v_fma_f32 v158, v158, s34, -v24
    v_mfma_f32_32x32x16_bf16 v[112:127], v[220:223], v[136:139], v[112:127]
    ds_read_b64_tr_b16 v[220:221], v19 offset:12288
    ds_read_b64_tr_b16 v[222:223], v19 offset:14336
    v_fma_f32 v159, v159, s34, -v24
    v_exp_f32 v152, v152
    v_exp_f32 v153, v153
    v_exp_f32 v154, v154
    v_exp_f32 v155, v155
    s_waitcnt lgkmcnt(8)
    v_mfma_f32_32x32x16_bf16 v[64:79], v[224:227], v[144:147], v[64:79]
    ds_read_b64_tr_b16 v[224:225], v20 offset:12288
    ds_read_b64_tr_b16 v[226:227], v20 offset:14336
    v_exp_f32 v156, v156
    v_exp_f32 v157, v157
    v_exp_f32 v158, v158
    v_exp_f32 v159, v159
    v_add_f32 v23, v23, v152
    v_mfma_f32_32x32x16_bf16 v[80:95], v[228:231], v[144:147], v[80:95]
    ds_read_b64_tr_b16 v[228:229], v21 offset:12288
    ds_read_b64_tr_b16 v[230:231], v21 offset:14336
    v_add_f32 v9, v9, v153
    v_add_f32 v23, v23, v154
    v_add_f32 v9, v9, v155
    v_add_f32 v23, v23, v156
    v_add_f32 v9, v9, v157
    s_waitcnt lgkmcnt(8)
    v_mfma_f32_32x32x16_bf16 v[96:111], v[232:235], v[144:147], v[96:111]
    v_add_f32 v23, v23, v158
    v_add_f32 v9, v9, v159
    v_cvt_pk_bf16_f32 v152, v152, v153
    v_cvt_pk_bf16_f32 v153, v154, v155
    v_cvt_pk_bf16_f32 v154, v156, v157
    v_cvt_pk_bf16_f32 v155, v158, v159
    v_mfma_f32_32x32x16_bf16 v[112:127], v[236:239], v[144:147], v[112:127]
    s_waitcnt lgkmcnt(4)
    v_mfma_f32_32x32x16_bf16 v[64:79], v[216:219], v[152:155], v[64:79]
    v_mfma_f32_32x32x16_bf16 v[80:95], v[220:223], v[152:155], v[80:95]
    s_waitcnt lgkmcnt(0)
    v_mfma_f32_32x32x16_bf16 v[96:111], v[224:227], v[152:155], v[96:111]
    v_mfma_f32_32x32x16_bf16 v[112:127], v[228:231], v[152:155], v[112:127]
    s_barrier
    v_add_u32 v10, 49152, v28
    v_xor_b32 v11, 32, v10
    v_xor_b32 v12, 64, v10
    v_xor_b32 v13, 96, v10
    v_xor_b32 v14, 128, v10
    v_xor_b32 v15, 160, v10
    v_xor_b32 v16, 192, v10
    v_xor_b32 v17, 224, v10
    ds_read_b128 v[192:195], v10 offset:0
    ds_read_b128 v[196:199], v11 offset:0
    ds_read_b128 v[200:203], v12 offset:0
    ds_read_b128 v[204:207], v13 offset:0
    ds_read_b128 v[208:211], v14 offset:0
    ds_read_b128 v[212:215], v15 offset:0
    v_add_u32 v18, 65536, v29
    v_xor_b32 v19, 64, v18
    v_xor_b32 v20, 128, v18
    v_xor_b32 v21, 192, v18
    v_max3_f32 v26, v160, v161, v162
    v_max3_f32 v27, v176, v177, v178
    v_max3_f32 v26, v26, v163, v164
    v_max3_f32 v27, v27, v179, v180
    v_max3_f32 v26, v26, v165, v166
    v_max3_f32 v27, v27, v181, v182
    v_max3_f32 v26, v26, v167, v168
    v_max3_f32 v27, v27, v183, v184
    v_max3_f32 v26, v26, v169, v170
    v_max3_f32 v27, v27, v185, v186
    v_max3_f32 v26, v26, v171, v172
    v_max3_f32 v27, v27, v187, v188
    v_max3_f32 v26, v26, v173, v174
    v_max3_f32 v27, v27, v189, v190
    v_max_f32 v26, v26, v175
    v_max_f32 v27, v27, v191
    s_waitcnt lgkmcnt(4)
    v_mfma_f32_32x32x16_bf16 v[128:143], v[192:195], v[32:35], 0
    ds_read_b128 v[192:195], v16 offset:0
    v_max_f32 v26, v26, v27
    v_mov_b32 v27, v26
    s_nop 1
    v_permlane32_swap_b32 v26, v27
    v_mfma_f32_32x32x16_bf16 v[128:143], v[196:199], v[36:39], v[128:143]
    ds_read_b128 v[196:199], v17 offset:0
    v_max_f32 v26, v26, v27
    v_sub_f32 v27, v26, v22
    v_cmp_lt_f32 vcc, s61, v27
    s_nop 4
    s_cbranch_vccz attn_kernel_lz19
    v_max_f32 v26, v26, v22
    v_sub_f32 v27, v22, v26
    v_mul_f32 v27, s34, v27
    v_exp_f32 v25, v27
    v_mov_b32 v22, v26
    v_mul_f32 v24, s34, v26
    v_mul_f32 v23, v23, v25
    v_mul_f32 v9, v9, v25
    s_nop 11
    v_mul_f32 v64, v64, v25
    v_mul_f32 v65, v65, v25
    v_mul_f32 v66, v66, v25
    v_mul_f32 v67, v67, v25
    v_mul_f32 v68, v68, v25
    v_mul_f32 v69, v69, v25
    v_mul_f32 v70, v70, v25
    v_mul_f32 v71, v71, v25
    v_mul_f32 v72, v72, v25
    v_mul_f32 v73, v73, v25
    v_mul_f32 v74, v74, v25
    v_mul_f32 v75, v75, v25
    v_mul_f32 v76, v76, v25
    v_mul_f32 v77, v77, v25
    v_mul_f32 v78, v78, v25
    v_mul_f32 v79, v79, v25
    v_mul_f32 v80, v80, v25
    v_mul_f32 v81, v81, v25
    v_mul_f32 v82, v82, v25
    v_mul_f32 v83, v83, v25
    v_mul_f32 v84, v84, v25
    v_mul_f32 v85, v85, v25
    v_mul_f32 v86, v86, v25
    v_mul_f32 v87, v87, v25
    v_mul_f32 v88, v88, v25
    v_mul_f32 v89, v89, v25
    v_mul_f32 v90, v90, v25
    v_mul_f32 v91, v91, v25
    v_mul_f32 v92, v92, v25
    v_mul_f32 v93, v93, v25
    v_mul_f32 v94, v94, v25
    v_mul_f32 v95, v95, v25
    v_mul_f32 v96, v96, v25
    v_mul_f32 v97, v97, v25
    v_mul_f32 v98, v98, v25
    v_mul_f32 v99, v99, v25
    v_mul_f32 v100, v100, v25
    v_mul_f32 v101, v101, v25
    v_mul_f32 v102, v102, v25
    v_mul_f32 v103, v103, v25
    v_mul_f32 v104, v104, v25
    v_mul_f32 v105, v105, v25
    v_mul_f32 v106, v106, v25
    v_mul_f32 v107, v107, v25
    v_mul_f32 v108, v108, v25
    v_mul_f32 v109, v109, v25
    v_mul_f32 v110, v110, v25
    v_mul_f32 v111, v111, v25
    v_mul_f32 v112, v112, v25
    v_mul_f32 v113, v113, v25
    v_mul_f32 v114, v114, v25
    v_mul_f32 v115, v115, v25
    v_mul_f32 v116, v116, v25
    v_mul_f32 v117, v117, v25
    v_mul_f32 v118, v118, v25
    v_mul_f32 v119, v119, v25
    v_mul_f32 v120, v120, v25
    v_mul_f32 v121, v121, v25
    v_mul_f32 v122, v122, v25
    v_mul_f32 v123, v123, v25
    v_mul_f32 v124, v124, v25
    v_mul_f32 v125, v125, v25
    v_mul_f32 v126, v126, v25
    v_mul_f32 v127, v127, v25
    s_nop 1
attn_kernel_lz19:
    v_fma_f32 v160, v160, s34, -v24
    s_waitcnt lgkmcnt(4)
    v_mfma_f32_32x32x16_bf16 v[128:143], v[200:203], v[40:43], v[128:143]
    ds_read_b128 v[200:203], v10 offset:8192
    v_fma_f32 v161, v161, s34, -v24
    v_fma_f32 v162, v162, s34, -v24
    v_fma_f32 v163, v163, s34, -v24
    v_fma_f32 v164, v164, s34, -v24
    v_mfma_f32_32x32x16_bf16 v[128:143], v[204:207], v[44:47], v[128:143]
    ds_read_b128 v[204:207], v11 offset:8192
    v_fma_f32 v165, v165, s34, -v24
    v_fma_f32 v166, v166, s34, -v24
    v_fma_f32 v167, v167, s34, -v24
    v_exp_f32 v160, v160
    s_waitcnt lgkmcnt(4)
    v_mfma_f32_32x32x16_bf16 v[128:143], v[208:211], v[48:51], v[128:143]
    ds_read_b128 v[208:211], v12 offset:8192
    v_exp_f32 v161, v161
    v_exp_f32 v162, v162
    v_exp_f32 v163, v163
    v_exp_f32 v164, v164
    v_mfma_f32_32x32x16_bf16 v[128:143], v[212:215], v[52:55], v[128:143]
    ds_read_b128 v[212:215], v13 offset:8192
    v_exp_f32 v165, v165
    v_exp_f32 v166, v166
    v_exp_f32 v167, v167
    v_add_f32 v23, v23, v160
    s_waitcnt lgkmcnt(4)
    v_mfma_f32_32x32x16_bf16 v[128:143], v[192:195], v[56:59], v[128:143]
    ds_read_b128 v[192:195], v14 offset:8192
    v_add_f32 v9, v9, v161
    v_add_f32 v23, v23, v162
    v_add_f32 v9, v9, v163
    v_add_f32 v23, v23, v164
    v_mfma_f32_32x32x16_bf16 v[128:143], v[196:199], v[60:63], v[128:143]
    ds_read_b128 v[196:199], v15 offset:8192
    v_add_f32 v9, v9, v165
    v_add_f32 v23, v23, v166
    v_add_f32 v9, v9, v167
    v_cvt_pk_bf16_f32 v160, v160, v161
    s_waitcnt lgkmcnt(4)
    v_mfma_f32_32x32x16_bf16 v[144:159], v[200:203], v[32:35], 0
    ds_read_b128 v[200:203], v16 offset:8192
    v_cvt_pk_bf16_f32 v161, v162, v163
    v_cvt_pk_bf16_f32 v162, v164, v165
    v_cvt_pk_bf16_f32 v163, v166, v167
    v_mfma_f32_32x32x16_bf16 v[144:159], v[204:207], v[36:39], v[144:159]
    ds_read_b128 v[204:207], v17 offset:8192
    v_fma_f32 v168, v168, s34, -v24
    v_fma_f32 v169, v169, s34, -v24
    v_fma_f32 v170, v170, s34, -v24
    v_fma_f32 v171, v171, s34, -v24
    s_waitcnt lgkmcnt(4)
    v_mfma_f32_32x32x16_bf16 v[144:159], v[208:211], v[40:43], v[144:159]
    ds_read_b64_tr_b16 v[216:217], v18 offset:0
    ds_read_b64_tr_b16 v[218:219], v18 offset:2048
    v_fma_f32 v172, v172, s34, -v24
    v_fma_f32 v173, v173, s34, -v24
    v_fma_f32 v174, v174, s34, -v24
    v_fma_f32 v175, v175, s34, -v24
    v_mfma_f32_32x32x16_bf16 v[144:159], v[212:215], v[44:47], v[144:159]
    ds_read_b64_tr_b16 v[220:221], v19 offset:0
    ds_read_b64_tr_b16 v[222:223], v19 offset:2048
    v_exp_f32 v168, v168
    v_exp_f32 v169, v169
    v_exp_f32 v170, v170
    v_exp_f32 v171, v171
    s_waitcnt lgkmcnt(6)
    v_mfma_f32_32x32x16_bf16 v[144:159], v[192:195], v[48:51], v[144:159]
    ds_read_b64_tr_b16 v[224:225], v20 offset:0
    ds_read_b64_tr_b16 v[226:227], v20 offset:2048
    v_exp_f32 v172, v172
    v_exp_f32 v173, v173
    v_exp_f32 v174, v174
    v_exp_f32 v175, v175
    v_mfma_f32_32x32x16_bf16 v[144:159], v[196:199], v[52:55], v[144:159]
    ds_read_b64_tr_b16 v[228:229], v21 offset:0
    ds_read_b64_tr_b16 v[230:231], v21 offset:2048
    v_add_f32 v23, v23, v168
    v_add_f32 v9, v9, v169
    v_add_f32 v23, v23, v170
    v_add_f32 v9, v9, v171
    s_waitcnt lgkmcnt(8)
    v_mfma_f32_32x32x16_bf16 v[144:159], v[200:203], v[56:59], v[144:159]
    ds_read_b64_tr_b16 v[232:233], v18 offset:4096
    ds_read_b64_tr_b16 v[234:235], v18 offset:6144
    v_add_f32 v23, v23, v172
    v_add_f32 v9, v9, v173
    v_add_f32 v23, v23, v174
    v_add_f32 v9, v9, v175
    v_mfma_f32_32x32x16_bf16 v[144:159], v[204:207], v[60:63], v[144:159]
    ds_read_b64_tr_b16 v[236:237], v19 offset:4096
    ds_read_b64_tr_b16 v[238:239], v19 offset:6144
    v_cvt_pk_bf16_f32 v168, v168, v169
    v_cvt_pk_bf16_f32 v169, v170, v171
    v_cvt_pk_bf16_f32 v170, v172, v173
    v_cvt_pk_bf16_f32 v171, v174, v175
    s_waitcnt lgkmcnt(8)
    v_mfma_f32_32x32x16_bf16 v[64:79], v[216:219], v[160:163], v[64:79]
    ds_read_b64_tr_b16 v[216:217], v20 offset:4096
    ds_read_b64_tr_b16 v[218:219], v20 offset:6144
    v_fma_f32 v176, v176, s34, -v24
    v_fma_f32 v177, v177, s34, -v24
    v_fma_f32 v178, v178, s34, -v24
    v_fma_f32 v179, v179, s34, -v24
    v_fma_f32 v180, v180, s34, -v24
    v_mfma_f32_32x32x16_bf16 v[80:95], v[220:223], v[160:163], v[80:95]
    ds_read_b64_tr_b16 v[220:221], v21 offset:4096
    ds_read_b64_tr_b16 v[222:223], v21 offset:6144
    v_fma_f32 v181, v181, s34, -v24
    v_fma_f32 v182, v182, s34, -v24
    v_fma_f32 v183, v183, s34, -v24
    v_exp_f32 v176, v176
    v_exp_f32 v177, v177
    s_waitcnt lgkmcnt(8)
    v_mfma_f32_32x32x16_bf16 v[96:111], v[224:227], v[160:163], v[96:111]
    ds_read_b64_tr_b16 v[224:225], v18 offset:8192
    ds_read_b64_tr_b16 v[226:227], v18 offset:10240
    v_exp_f32 v178, v178
    v_exp_f32 v179, v179
    v_exp_f32 v180, v180
    v_exp_f32 v181, v181
    v_exp_f32 v182, v182
    v_mfma_f32_32x32x16_bf16 v[112:127], v[228:231], v[160:163], v[112:127]
    ds_read_b64_tr_b16 v[228:229], v19 offset:8192
    ds_read_b64_tr_b16 v[230:231], v19 offset:10240
    v_exp_f32 v183, v183
    v_add_f32 v23, v23, v176
    v_add_f32 v9, v9, v177
    v_add_f32 v23, v23, v178
    v_add_f32 v9, v9, v179
    s_waitcnt lgkmcnt(8)
    v_mfma_f32_32x32x16_bf16 v[64:79], v[232:235], v[168:171], v[64:79]
    ds_read_b64_tr_b16 v[232:233], v20 offset:8192
    ds_read_b64_tr_b16 v[234:235], v20 offset:10240
    v_add_f32 v23, v23, v180
    v_add_f32 v9, v9, v181
    v_add_f32 v23, v23, v182
    v_add_f32 v9, v9, v183
    v_cvt_pk_bf16_f32 v176, v176, v177
    v_mfma_f32_32x32x16_bf16 v[80:95], v[236:239], v[168:171], v[80:95]
    ds_read_b64_tr_b16 v[236:237], v21 offset:8192
    ds_read_b64_tr_b16 v[238:239], v21 offset:10240
    v_cvt_pk_bf16_f32 v177, v178, v179
    v_cvt_pk_bf16_f32 v178, v180, v181
    v_cvt_pk_bf16_f32 v179, v182, v183
    v_fma_f32 v184, v184, s34, -v24
    v_fma_f32 v185, v185, s34, -v24
    s_waitcnt lgkmcnt(8)
    v_mfma_f32_32x32x16_bf16 v[96:111], v[216:219], v[168:171], v[96:111]
    ds_read_b64_tr_b16 v[216:217], v18 offset:12288
    ds_read_b64_tr_b16 v[218:219], v18 offset:14336
    v_fma_f32 v186, v186, s34, -v24
    v_fma_f32 v187, v187, s34, -v24
    v_fma_f32 v188, v188, s34, -v24
    v_fma_f32 v189, v189, s34, -v24
    v_fma_f32 v190, v190, s34, -v24
    v_mfma_f32_32x32x16_bf16 v[112:127], v[220:223], v[168:171], v[112:127]
    ds_read_b64_tr_b16 v[220:221], v19 offset:12288
    ds_read_b64_tr_b16 v[222:223], v19 offset:14336
    v_fma_f32 v191, v191, s34, -v24
    v_exp_f32 v184, v184
    v_exp_f32 v185, v185
    v_exp_f32 v186, v186
    v_exp_f32 v187, v187
    s_waitcnt lgkmcnt(8)
    v_mfma_f32_32x32x16_bf16 v[64:79], v[224:227], v[176:179], v[64:79]
    ds_read_b64_tr_b16 v[224:225], v20 offset:12288
    ds_read_b64_tr_b16 v[226:227], v20 offset:14336
    v_exp_f32 v188, v188
    v_exp_f32 v189, v189
    v_exp_f32 v190, v190
    v_exp_f32 v191, v191
    v_add_f32 v23, v23, v184
    v_mfma_f32_32x32x16_bf16 v[80:95], v[228:231], v[176:179], v[80:95]
    ds_read_b64_tr_b16 v[228:229], v21 offset:12288
    ds_read_b64_tr_b16 v[230:231], v21 offset:14336
    v_add_f32 v9, v9, v185
    v_add_f32 v23, v23, v186
    v_add_f32 v9, v9, v187
    v_add_f32 v23, v23, v188
    v_add_f32 v9, v9, v189
    s_waitcnt lgkmcnt(8)
    v_mfma_f32_32x32x16_bf16 v[96:111], v[232:235], v[176:179], v[96:111]
    v_add_f32 v23, v23, v190
    v_add_f32 v9, v9, v191
    v_cvt_pk_bf16_f32 v184, v184, v185
    v_cvt_pk_bf16_f32 v185, v186, v187
    v_cvt_pk_bf16_f32 v186, v188, v189
    v_cvt_pk_bf16_f32 v187, v190, v191
    v_mfma_f32_32x32x16_bf16 v[112:127], v[236:239], v[176:179], v[112:127]
    s_waitcnt lgkmcnt(4)
    v_mfma_f32_32x32x16_bf16 v[64:79], v[216:219], v[184:187], v[64:79]
    v_mfma_f32_32x32x16_bf16 v[80:95], v[220:223], v[184:187], v[80:95]
    s_waitcnt lgkmcnt(0)
    v_mfma_f32_32x32x16_bf16 v[96:111], v[224:227], v[184:187], v[96:111]
    v_mfma_f32_32x32x16_bf16 v[112:127], v[228:231], v[184:187], v[112:127]
    s_barrier
    v_add_u32 v10, 81920, v28
    v_xor_b32 v11, 32, v10
    v_xor_b32 v12, 64, v10
    v_xor_b32 v13, 96, v10
    v_xor_b32 v14, 128, v10
    v_xor_b32 v15, 160, v10
    v_xor_b32 v16, 192, v10
    v_xor_b32 v17, 224, v10
    ds_read_b128 v[192:195], v10 offset:0
    ds_read_b128 v[196:199], v11 offset:0
    ds_read_b128 v[200:203], v12 offset:0
    ds_read_b128 v[204:207], v13 offset:0
    ds_read_b128 v[208:211], v14 offset:0
    ds_read_b128 v[212:215], v15 offset:0
    v_add_u32 v18, 98304, v29
    v_xor_b32 v19, 64, v18
    v_xor_b32 v20, 128, v18
    v_xor_b32 v21, 192, v18
    v_max3_f32 v26, v128, v129, v130
    v_max3_f32 v27, v144, v145, v146
    v_max3_f32 v26, v26, v131, v132
    v_max3_f32 v27, v27, v147, v148
    v_max3_f32 v26, v26, v133, v134
    v_max3_f32 v27, v27, v149, v150
    v_max3_f32 v26, v26, v135, v136
    v_max3_f32 v27, v27, v151, v152
    v_max3_f32 v26, v26, v137, v138
    v_max3_f32 v27, v27, v153, v154
    v_max3_f32 v26, v26, v139, v140
    v_max3_f32 v27, v27, v155, v156
    v_max3_f32 v26, v26, v141, v142
    v_max3_f32 v27, v27, v157, v158
    v_max_f32 v26, v26, v143
    v_max_f32 v27, v27, v159
    s_waitcnt lgkmcnt(4)
    v_mfma_f32_32x32x16_bf16 v[160:175], v[192:195], v[32:35], 0
    ds_read_b128 v[192:195], v16 offset:0
    v_max_f32 v26, v26, v27
    v_mov_b32 v27, v26
    s_nop 1
    v_permlane32_swap_b32 v26, v27
    v_mfma_f32_32x32x16_bf16 v[160:175], v[196:199], v[36:39], v[160:175]
    ds_read_b128 v[196:199], v17 offset:0
    v_max_f32 v26, v26, v27
    v_sub_f32 v27, v26, v22
    v_cmp_lt_f32 vcc, s61, v27
    s_nop 4
    s_cbranch_vccz attn_kernel_lz20
    v_max_f32 v26, v26, v22
    v_sub_f32 v27, v22, v26
    v_mul_f32 v27, s34, v27
    v_exp_f32 v25, v27
    v_mov_b32 v22, v26
    v_mul_f32 v24, s34, v26
    v_mul_f32 v23, v23, v25
    v_mul_f32 v9, v9, v25
    s_nop 11
    v_mul_f32 v64, v64, v25
    v_mul_f32 v65, v65, v25
    v_mul_f32 v66, v66, v25
    v_mul_f32 v67, v67, v25
    v_mul_f32 v68, v68, v25
    v_mul_f32 v69, v69, v25
    v_mul_f32 v70, v70, v25
    v_mul_f32 v71, v71, v25
    v_mul_f32 v72, v72, v25
    v_mul_f32 v73, v73, v25
    v_mul_f32 v74, v74, v25
    v_mul_f32 v75, v75, v25
    v_mul_f32 v76, v76, v25
    v_mul_f32 v77, v77, v25
    v_mul_f32 v78, v78, v25
    v_mul_f32 v79, v79, v25
    v_mul_f32 v80, v80, v25
    v_mul_f32 v81, v81, v25
    v_mul_f32 v82, v82, v25
    v_mul_f32 v83, v83, v25
    v_mul_f32 v84, v84, v25
    v_mul_f32 v85, v85, v25
    v_mul_f32 v86, v86, v25
    v_mul_f32 v87, v87, v25
    v_mul_f32 v88, v88, v25
    v_mul_f32 v89, v89, v25
    v_mul_f32 v90, v90, v25
    v_mul_f32 v91, v91, v25
    v_mul_f32 v92, v92, v25
    v_mul_f32 v93, v93, v25
    v_mul_f32 v94, v94, v25
    v_mul_f32 v95, v95, v25
    v_mul_f32 v96, v96, v25
    v_mul_f32 v97, v97, v25
    v_mul_f32 v98, v98, v25
    v_mul_f32 v99, v99, v25
    v_mul_f32 v100, v100, v25
    v_mul_f32 v101, v101, v25
    v_mul_f32 v102, v102, v25
    v_mul_f32 v103, v103, v25
    v_mul_f32 v104, v104, v25
    v_mul_f32 v105, v105, v25
    v_mul_f32 v106, v106, v25
    v_mul_f32 v107, v107, v25
    v_mul_f32 v108, v108, v25
    v_mul_f32 v109, v109, v25
    v_mul_f32 v110, v110, v25
    v_mul_f32 v111, v111, v25
    v_mul_f32 v112, v112, v25
    v_mul_f32 v113, v113, v25
    v_mul_f32 v114, v114, v25
    v_mul_f32 v115, v115, v25
    v_mul_f32 v116, v116, v25
    v_mul_f32 v117, v117, v25
    v_mul_f32 v118, v118, v25
    v_mul_f32 v119, v119, v25
    v_mul_f32 v120, v120, v25
    v_mul_f32 v121, v121, v25
    v_mul_f32 v122, v122, v25
    v_mul_f32 v123, v123, v25
    v_mul_f32 v124, v124, v25
    v_mul_f32 v125, v125, v25
    v_mul_f32 v126, v126, v25
    v_mul_f32 v127, v127, v25
    s_nop 1
attn_kernel_lz20:
    v_fma_f32 v128, v128, s34, -v24
    s_waitcnt lgkmcnt(4)
    v_mfma_f32_32x32x16_bf16 v[160:175], v[200:203], v[40:43], v[160:175]
    ds_read_b128 v[200:203], v10 offset:8192
    v_fma_f32 v129, v129, s34, -v24
    v_fma_f32 v130, v130, s34, -v24
    v_fma_f32 v131, v131, s34, -v24
    v_fma_f32 v132, v132, s34, -v24
    v_mfma_f32_32x32x16_bf16 v[160:175], v[204:207], v[44:47], v[160:175]
    ds_read_b128 v[204:207], v11 offset:8192
    v_fma_f32 v133, v133, s34, -v24
    v_fma_f32 v134, v134, s34, -v24
    v_fma_f32 v135, v135, s34, -v24
    v_exp_f32 v128, v128
    s_waitcnt lgkmcnt(4)
    v_mfma_f32_32x32x16_bf16 v[160:175], v[208:211], v[48:51], v[160:175]
    ds_read_b128 v[208:211], v12 offset:8192
    v_exp_f32 v129, v129
    v_exp_f32 v130, v130
    v_exp_f32 v131, v131
    v_exp_f32 v132, v132
    v_mfma_f32_32x32x16_bf16 v[160:175], v[212:215], v[52:55], v[160:175]
    ds_read_b128 v[212:215], v13 offset:8192
    v_exp_f32 v133, v133
    v_exp_f32 v134, v134
    v_exp_f32 v135, v135
    v_add_f32 v23, v23, v128
    s_waitcnt lgkmcnt(4)
    v_mfma_f32_32x32x16_bf16 v[160:175], v[192:195], v[56:59], v[160:175]
    ds_read_b128 v[192:195], v14 offset:8192
    v_add_f32 v9, v9, v129
    v_add_f32 v23, v23, v130
    v_add_f32 v9, v9, v131
    v_add_f32 v23, v23, v132
    v_mfma_f32_32x32x16_bf16 v[160:175], v[196:199], v[60:63], v[160:175]
    ds_read_b128 v[196:199], v15 offset:8192
    v_add_f32 v9, v9, v133
    v_add_f32 v23, v23, v134
    v_add_f32 v9, v9, v135
    v_cvt_pk_bf16_f32 v128, v128, v129
    s_waitcnt lgkmcnt(4)
    v_mfma_f32_32x32x16_bf16 v[176:191], v[200:203], v[32:35], 0
    ds_read_b128 v[200:203], v16 offset:8192
    v_cvt_pk_bf16_f32 v129, v130, v131
    v_cvt_pk_bf16_f32 v130, v132, v133
    v_cvt_pk_bf16_f32 v131, v134, v135
    v_mfma_f32_32x32x16_bf16 v[176:191], v[204:207], v[36:39], v[176:191]
    ds_read_b128 v[204:207], v17 offset:8192
    v_fma_f32 v136, v136, s34, -v24
    v_fma_f32 v137, v137, s34, -v24
    v_fma_f32 v138, v138, s34, -v24
    v_fma_f32 v139, v139, s34, -v24
    s_waitcnt lgkmcnt(4)
    v_mfma_f32_32x32x16_bf16 v[176:191], v[208:211], v[40:43], v[176:191]
    ds_read_b64_tr_b16 v[216:217], v18 offset:0
    ds_read_b64_tr_b16 v[218:219], v18 offset:2048
    v_fma_f32 v140, v140, s34, -v24
    v_fma_f32 v141, v141, s34, -v24
    v_fma_f32 v142, v142, s34, -v24
    v_fma_f32 v143, v143, s34, -v24
    v_mfma_f32_32x32x16_bf16 v[176:191], v[212:215], v[44:47], v[176:191]
    ds_read_b64_tr_b16 v[220:221], v19 offset:0
    ds_read_b64_tr_b16 v[222:223], v19 offset:2048
    v_exp_f32 v136, v136
    v_exp_f32 v137, v137
    v_exp_f32 v138, v138
    v_exp_f32 v139, v139
    s_waitcnt lgkmcnt(6)
    v_mfma_f32_32x32x16_bf16 v[176:191], v[192:195], v[48:51], v[176:191]
    ds_read_b64_tr_b16 v[224:225], v20 offset:0
    ds_read_b64_tr_b16 v[226:227], v20 offset:2048
    v_exp_f32 v140, v140
    v_exp_f32 v141, v141
    v_exp_f32 v142, v142
    v_exp_f32 v143, v143
    v_mfma_f32_32x32x16_bf16 v[176:191], v[196:199], v[52:55], v[176:191]
    ds_read_b64_tr_b16 v[228:229], v21 offset:0
    ds_read_b64_tr_b16 v[230:231], v21 offset:2048
    v_add_f32 v23, v23, v136
    v_add_f32 v9, v9, v137
    v_add_f32 v23, v23, v138
    v_add_f32 v9, v9, v139
    s_waitcnt lgkmcnt(8)
    v_mfma_f32_32x32x16_bf16 v[176:191], v[200:203], v[56:59], v[176:191]
    ds_read_b64_tr_b16 v[232:233], v18 offset:4096
    ds_read_b64_tr_b16 v[234:235], v18 offset:6144
    v_add_f32 v23, v23, v140
    v_add_f32 v9, v9, v141
    v_add_f32 v23, v23, v142
    v_add_f32 v9, v9, v143
    v_mfma_f32_32x32x16_bf16 v[176:191], v[204:207], v[60:63], v[176:191]
    ds_read_b64_tr_b16 v[236:237], v19 offset:4096
    ds_read_b64_tr_b16 v[238:239], v19 offset:6144
    v_cvt_pk_bf16_f32 v136, v136, v137
    v_cvt_pk_bf16_f32 v137, v138, v139
    v_cvt_pk_bf16_f32 v138, v140, v141
    v_cvt_pk_bf16_f32 v139, v142, v143
    s_waitcnt lgkmcnt(8)
    v_mfma_f32_32x32x16_bf16 v[64:79], v[216:219], v[128:131], v[64:79]
    ds_read_b64_tr_b16 v[216:217], v20 offset:4096
    ds_read_b64_tr_b16 v[218:219], v20 offset:6144
    v_fma_f32 v144, v144, s34, -v24
    v_fma_f32 v145, v145, s34, -v24
    v_fma_f32 v146, v146, s34, -v24
    v_fma_f32 v147, v147, s34, -v24
    v_fma_f32 v148, v148, s34, -v24
    v_mfma_f32_32x32x16_bf16 v[80:95], v[220:223], v[128:131], v[80:95]
    ds_read_b64_tr_b16 v[220:221], v21 offset:4096
    ds_read_b64_tr_b16 v[222:223], v21 offset:6144
    v_fma_f32 v149, v149, s34, -v24
    v_fma_f32 v150, v150, s34, -v24
    v_fma_f32 v151, v151, s34, -v24
    v_exp_f32 v144, v144
    v_exp_f32 v145, v145
    s_waitcnt lgkmcnt(8)
    v_mfma_f32_32x32x16_bf16 v[96:111], v[224:227], v[128:131], v[96:111]
    ds_read_b64_tr_b16 v[224:225], v18 offset:8192
    ds_read_b64_tr_b16 v[226:227], v18 offset:10240
    v_exp_f32 v146, v146
    v_exp_f32 v147, v147
    v_exp_f32 v148, v148
    v_exp_f32 v149, v149
    v_exp_f32 v150, v150
    v_mfma_f32_32x32x16_bf16 v[112:127], v[228:231], v[128:131], v[112:127]
    ds_read_b64_tr_b16 v[228:229], v19 offset:8192
    ds_read_b64_tr_b16 v[230:231], v19 offset:10240
    v_exp_f32 v151, v151
    v_add_f32 v23, v23, v144
    v_add_f32 v9, v9, v145
    v_add_f32 v23, v23, v146
    v_add_f32 v9, v9, v147
    s_waitcnt lgkmcnt(8)
    v_mfma_f32_32x32x16_bf16 v[64:79], v[232:235], v[136:139], v[64:79]
    ds_read_b64_tr_b16 v[232:233], v20 offset:8192
    ds_read_b64_tr_b16 v[234:235], v20 offset:10240
    v_add_f32 v23, v23, v148
    v_add_f32 v9, v9, v149
    v_add_f32 v23, v23, v150
    v_add_f32 v9, v9, v151
    v_cvt_pk_bf16_f32 v144, v144, v145
    v_mfma_f32_32x32x16_bf16 v[80:95], v[236:239], v[136:139], v[80:95]
    ds_read_b64_tr_b16 v[236:237], v21 offset:8192
    ds_read_b64_tr_b16 v[238:239], v21 offset:10240
    v_cvt_pk_bf16_f32 v145, v146, v147
    v_cvt_pk_bf16_f32 v146, v148, v149
    v_cvt_pk_bf16_f32 v147, v150, v151
    v_fma_f32 v152, v152, s34, -v24
    v_fma_f32 v153, v153, s34, -v24
    s_waitcnt lgkmcnt(8)
    v_mfma_f32_32x32x16_bf16 v[96:111], v[216:219], v[136:139], v[96:111]
    ds_read_b64_tr_b16 v[216:217], v18 offset:12288
    ds_read_b64_tr_b16 v[218:219], v18 offset:14336
    v_fma_f32 v154, v154, s34, -v24
    v_fma_f32 v155, v155, s34, -v24
    v_fma_f32 v156, v156, s34, -v24
    v_fma_f32 v157, v157, s34, -v24
    v_fma_f32 v158, v158, s34, -v24
    v_mfma_f32_32x32x16_bf16 v[112:127], v[220:223], v[136:139], v[112:127]
    ds_read_b64_tr_b16 v[220:221], v19 offset:12288
    ds_read_b64_tr_b16 v[222:223], v19 offset:14336
    v_fma_f32 v159, v159, s34, -v24
    v_exp_f32 v152, v152
    v_exp_f32 v153, v153
    v_exp_f32 v154, v154
    v_exp_f32 v155, v155
    s_waitcnt lgkmcnt(8)
    v_mfma_f32_32x32x16_bf16 v[64:79], v[224:227], v[144:147], v[64:79]
    ds_read_b64_tr_b16 v[224:225], v20 offset:12288
    ds_read_b64_tr_b16 v[226:227], v20 offset:14336
    v_exp_f32 v156, v156
    v_exp_f32 v157, v157
    v_exp_f32 v158, v158
    v_exp_f32 v159, v159
    v_add_f32 v23, v23, v152
    v_mfma_f32_32x32x16_bf16 v[80:95], v[228:231], v[144:147], v[80:95]
    ds_read_b64_tr_b16 v[228:229], v21 offset:12288
    ds_read_b64_tr_b16 v[230:231], v21 offset:14336
    v_add_f32 v9, v9, v153
    v_add_f32 v23, v23, v154
    v_add_f32 v9, v9, v155
    v_add_f32 v23, v23, v156
    v_add_f32 v9, v9, v157
    s_waitcnt lgkmcnt(8)
    v_mfma_f32_32x32x16_bf16 v[96:111], v[232:235], v[144:147], v[96:111]
    v_add_f32 v23, v23, v158
    v_add_f32 v9, v9, v159
    v_cvt_pk_bf16_f32 v152, v152, v153
    v_cvt_pk_bf16_f32 v153, v154, v155
    v_cvt_pk_bf16_f32 v154, v156, v157
    v_cvt_pk_bf16_f32 v155, v158, v159
    v_mfma_f32_32x32x16_bf16 v[112:127], v[236:239], v[144:147], v[112:127]
    s_waitcnt lgkmcnt(4)
    v_mfma_f32_32x32x16_bf16 v[64:79], v[216:219], v[152:155], v[64:79]
    v_mfma_f32_32x32x16_bf16 v[80:95], v[220:223], v[152:155], v[80:95]
    s_waitcnt lgkmcnt(0)
    v_mfma_f32_32x32x16_bf16 v[96:111], v[224:227], v[152:155], v[96:111]
    v_mfma_f32_32x32x16_bf16 v[112:127], v[228:231], v[152:155], v[112:127]
    s_barrier
    v_add_u32 v10, 114688, v28
    v_xor_b32 v11, 32, v10
    v_xor_b32 v12, 64, v10
    v_xor_b32 v13, 96, v10
    v_xor_b32 v14, 128, v10
    v_xor_b32 v15, 160, v10
    v_xor_b32 v16, 192, v10
    v_xor_b32 v17, 224, v10
    ds_read_b128 v[192:195], v10 offset:0
    ds_read_b128 v[196:199], v11 offset:0
    ds_read_b128 v[200:203], v12 offset:0
    ds_read_b128 v[204:207], v13 offset:0
    ds_read_b128 v[208:211], v14 offset:0
    ds_read_b128 v[212:215], v15 offset:0
    v_add_u32 v18, 131072, v29
    v_xor_b32 v19, 64, v18
    v_xor_b32 v20, 128, v18
    v_xor_b32 v21, 192, v18
    v_max3_f32 v26, v160, v161, v162
    v_max3_f32 v27, v176, v177, v178
    v_max3_f32 v26, v26, v163, v164
    v_max3_f32 v27, v27, v179, v180
    v_max3_f32 v26, v26, v165, v166
    v_max3_f32 v27, v27, v181, v182
    v_max3_f32 v26, v26, v167, v168
    v_max3_f32 v27, v27, v183, v184
    v_max3_f32 v26, v26, v169, v170
    v_max3_f32 v27, v27, v185, v186
    v_max3_f32 v26, v26, v171, v172
    v_max3_f32 v27, v27, v187, v188
    v_max3_f32 v26, v26, v173, v174
    v_max3_f32 v27, v27, v189, v190
    v_max_f32 v26, v26, v175
    v_max_f32 v27, v27, v191
    s_waitcnt lgkmcnt(4)
    v_mfma_f32_32x32x16_bf16 v[128:143], v[192:195], v[32:35], 0
    ds_read_b128 v[192:195], v16 offset:0
    v_max_f32 v26, v26, v27
    v_mov_b32 v27, v26
    s_nop 1
    v_permlane32_swap_b32 v26, v27
    v_mfma_f32_32x32x16_bf16 v[128:143], v[196:199], v[36:39], v[128:143]
    ds_read_b128 v[196:199], v17 offset:0
    v_max_f32 v26, v26, v27
    v_sub_f32 v27, v26, v22
    v_cmp_lt_f32 vcc, s61, v27
    s_nop 4
    s_cbranch_vccz attn_kernel_lz21
    v_max_f32 v26, v26, v22
    v_sub_f32 v27, v22, v26
    v_mul_f32 v27, s34, v27
    v_exp_f32 v25, v27
    v_mov_b32 v22, v26
    v_mul_f32 v24, s34, v26
    v_mul_f32 v23, v23, v25
    v_mul_f32 v9, v9, v25
    s_nop 11
    v_mul_f32 v64, v64, v25
    v_mul_f32 v65, v65, v25
    v_mul_f32 v66, v66, v25
    v_mul_f32 v67, v67, v25
    v_mul_f32 v68, v68, v25
    v_mul_f32 v69, v69, v25
    v_mul_f32 v70, v70, v25
    v_mul_f32 v71, v71, v25
    v_mul_f32 v72, v72, v25
    v_mul_f32 v73, v73, v25
    v_mul_f32 v74, v74, v25
    v_mul_f32 v75, v75, v25
    v_mul_f32 v76, v76, v25
    v_mul_f32 v77, v77, v25
    v_mul_f32 v78, v78, v25
    v_mul_f32 v79, v79, v25
    v_mul_f32 v80, v80, v25
    v_mul_f32 v81, v81, v25
    v_mul_f32 v82, v82, v25
    v_mul_f32 v83, v83, v25
    v_mul_f32 v84, v84, v25
    v_mul_f32 v85, v85, v25
    v_mul_f32 v86, v86, v25
    v_mul_f32 v87, v87, v25
    v_mul_f32 v88, v88, v25
    v_mul_f32 v89, v89, v25
    v_mul_f32 v90, v90, v25
    v_mul_f32 v91, v91, v25
    v_mul_f32 v92, v92, v25
    v_mul_f32 v93, v93, v25
    v_mul_f32 v94, v94, v25
    v_mul_f32 v95, v95, v25
    v_mul_f32 v96, v96, v25
    v_mul_f32 v97, v97, v25
    v_mul_f32 v98, v98, v25
    v_mul_f32 v99, v99, v25
    v_mul_f32 v100, v100, v25
    v_mul_f32 v101, v101, v25
    v_mul_f32 v102, v102, v25
    v_mul_f32 v103, v103, v25
    v_mul_f32 v104, v104, v25
    v_mul_f32 v105, v105, v25
    v_mul_f32 v106, v106, v25
    v_mul_f32 v107, v107, v25
    v_mul_f32 v108, v108, v25
    v_mul_f32 v109, v109, v25
    v_mul_f32 v110, v110, v25
    v_mul_f32 v111, v111, v25
    v_mul_f32 v112, v112, v25
    v_mul_f32 v113, v113, v25
    v_mul_f32 v114, v114, v25
    v_mul_f32 v115, v115, v25
    v_mul_f32 v116, v116, v25
    v_mul_f32 v117, v117, v25
    v_mul_f32 v118, v118, v25
    v_mul_f32 v119, v119, v25
    v_mul_f32 v120, v120, v25
    v_mul_f32 v121, v121, v25
    v_mul_f32 v122, v122, v25
    v_mul_f32 v123, v123, v25
    v_mul_f32 v124, v124, v25
    v_mul_f32 v125, v125, v25
    v_mul_f32 v126, v126, v25
    v_mul_f32 v127, v127, v25
    s_nop 1
attn_kernel_lz21:
    v_fma_f32 v160, v160, s34, -v24
    s_waitcnt lgkmcnt(4)
    v_mfma_f32_32x32x16_bf16 v[128:143], v[200:203], v[40:43], v[128:143]
    ds_read_b128 v[200:203], v10 offset:8192
    v_fma_f32 v161, v161, s34, -v24
    v_fma_f32 v162, v162, s34, -v24
    v_fma_f32 v163, v163, s34, -v24
    v_fma_f32 v164, v164, s34, -v24
    v_mfma_f32_32x32x16_bf16 v[128:143], v[204:207], v[44:47], v[128:143]
    ds_read_b128 v[204:207], v11 offset:8192
    v_fma_f32 v165, v165, s34, -v24
    v_fma_f32 v166, v166, s34, -v24
    v_fma_f32 v167, v167, s34, -v24
    v_exp_f32 v160, v160
    s_waitcnt lgkmcnt(4)
    v_mfma_f32_32x32x16_bf16 v[128:143], v[208:211], v[48:51], v[128:143]
    ds_read_b128 v[208:211], v12 offset:8192
    v_exp_f32 v161, v161
    v_exp_f32 v162, v162
    v_exp_f32 v163, v163
    v_exp_f32 v164, v164
    v_mfma_f32_32x32x16_bf16 v[128:143], v[212:215], v[52:55], v[128:143]
    ds_read_b128 v[212:215], v13 offset:8192
    v_exp_f32 v165, v165
    v_exp_f32 v166, v166
    v_exp_f32 v167, v167
    v_add_f32 v23, v23, v160
    s_waitcnt lgkmcnt(4)
    v_mfma_f32_32x32x16_bf16 v[128:143], v[192:195], v[56:59], v[128:143]
    ds_read_b128 v[192:195], v14 offset:8192
    v_add_f32 v9, v9, v161
    v_add_f32 v23, v23, v162
    v_add_f32 v9, v9, v163
    v_add_f32 v23, v23, v164
    v_mfma_f32_32x32x16_bf16 v[128:143], v[196:199], v[60:63], v[128:143]
    ds_read_b128 v[196:199], v15 offset:8192
    v_add_f32 v9, v9, v165
    v_add_f32 v23, v23, v166
    v_add_f32 v9, v9, v167
    v_cvt_pk_bf16_f32 v160, v160, v161
    s_waitcnt lgkmcnt(4)
    v_mfma_f32_32x32x16_bf16 v[144:159], v[200:203], v[32:35], 0
    ds_read_b128 v[200:203], v16 offset:8192
    v_cvt_pk_bf16_f32 v161, v162, v163
    v_cvt_pk_bf16_f32 v162, v164, v165
    v_cvt_pk_bf16_f32 v163, v166, v167
    v_mfma_f32_32x32x16_bf16 v[144:159], v[204:207], v[36:39], v[144:159]
    ds_read_b128 v[204:207], v17 offset:8192
    v_fma_f32 v168, v168, s34, -v24
    v_fma_f32 v169, v169, s34, -v24
    v_fma_f32 v170, v170, s34, -v24
    v_fma_f32 v171, v171, s34, -v24
    s_waitcnt lgkmcnt(4)
    v_mfma_f32_32x32x16_bf16 v[144:159], v[208:211], v[40:43], v[144:159]
    ds_read_b64_tr_b16 v[216:217], v18 offset:0
    ds_read_b64_tr_b16 v[218:219], v18 offset:2048
    v_fma_f32 v172, v172, s34, -v24
    v_fma_f32 v173, v173, s34, -v24
    v_fma_f32 v174, v174, s34, -v24
    v_fma_f32 v175, v175, s34, -v24
    v_mfma_f32_32x32x16_bf16 v[144:159], v[212:215], v[44:47], v[144:159]
    ds_read_b64_tr_b16 v[220:221], v19 offset:0
    ds_read_b64_tr_b16 v[222:223], v19 offset:2048
    v_exp_f32 v168, v168
    v_exp_f32 v169, v169
    v_exp_f32 v170, v170
    v_exp_f32 v171, v171
    s_waitcnt lgkmcnt(6)
    v_mfma_f32_32x32x16_bf16 v[144:159], v[192:195], v[48:51], v[144:159]
    ds_read_b64_tr_b16 v[224:225], v20 offset:0
    ds_read_b64_tr_b16 v[226:227], v20 offset:2048
    v_exp_f32 v172, v172
    v_exp_f32 v173, v173
    v_exp_f32 v174, v174
    v_exp_f32 v175, v175
    v_mfma_f32_32x32x16_bf16 v[144:159], v[196:199], v[52:55], v[144:159]
    ds_read_b64_tr_b16 v[228:229], v21 offset:0
    ds_read_b64_tr_b16 v[230:231], v21 offset:2048
    v_add_f32 v23, v23, v168
    v_add_f32 v9, v9, v169
    v_add_f32 v23, v23, v170
    v_add_f32 v9, v9, v171
    s_waitcnt lgkmcnt(8)
    v_mfma_f32_32x32x16_bf16 v[144:159], v[200:203], v[56:59], v[144:159]
    ds_read_b64_tr_b16 v[232:233], v18 offset:4096
    ds_read_b64_tr_b16 v[234:235], v18 offset:6144
    v_add_f32 v23, v23, v172
    v_add_f32 v9, v9, v173
    v_add_f32 v23, v23, v174
    v_add_f32 v9, v9, v175
    v_mfma_f32_32x32x16_bf16 v[144:159], v[204:207], v[60:63], v[144:159]
    ds_read_b64_tr_b16 v[236:237], v19 offset:4096
    ds_read_b64_tr_b16 v[238:239], v19 offset:6144
    v_cvt_pk_bf16_f32 v168, v168, v169
    v_cvt_pk_bf16_f32 v169, v170, v171
    v_cvt_pk_bf16_f32 v170, v172, v173
    v_cvt_pk_bf16_f32 v171, v174, v175
    s_waitcnt lgkmcnt(8)
    v_mfma_f32_32x32x16_bf16 v[64:79], v[216:219], v[160:163], v[64:79]
    ds_read_b64_tr_b16 v[216:217], v20 offset:4096
    ds_read_b64_tr_b16 v[218:219], v20 offset:6144
    v_fma_f32 v176, v176, s34, -v24
    v_fma_f32 v177, v177, s34, -v24
    v_fma_f32 v178, v178, s34, -v24
    v_fma_f32 v179, v179, s34, -v24
    v_fma_f32 v180, v180, s34, -v24
    v_mfma_f32_32x32x16_bf16 v[80:95], v[220:223], v[160:163], v[80:95]
    ds_read_b64_tr_b16 v[220:221], v21 offset:4096
    ds_read_b64_tr_b16 v[222:223], v21 offset:6144
    v_fma_f32 v181, v181, s34, -v24
    v_fma_f32 v182, v182, s34, -v24
    v_fma_f32 v183, v183, s34, -v24
    v_exp_f32 v176, v176
    v_exp_f32 v177, v177
    s_waitcnt lgkmcnt(8)
    v_mfma_f32_32x32x16_bf16 v[96:111], v[224:227], v[160:163], v[96:111]
    ds_read_b64_tr_b16 v[224:225], v18 offset:8192
    ds_read_b64_tr_b16 v[226:227], v18 offset:10240
    v_exp_f32 v178, v178
    v_exp_f32 v179, v179
    v_exp_f32 v180, v180
    v_exp_f32 v181, v181
    v_exp_f32 v182, v182
    v_mfma_f32_32x32x16_bf16 v[112:127], v[228:231], v[160:163], v[112:127]
    ds_read_b64_tr_b16 v[228:229], v19 offset:8192
    ds_read_b64_tr_b16 v[230:231], v19 offset:10240
    v_exp_f32 v183, v183
    v_add_f32 v23, v23, v176
    v_add_f32 v9, v9, v177
    v_add_f32 v23, v23, v178
    v_add_f32 v9, v9, v179
    s_waitcnt lgkmcnt(8)
    v_mfma_f32_32x32x16_bf16 v[64:79], v[232:235], v[168:171], v[64:79]
    ds_read_b64_tr_b16 v[232:233], v20 offset:8192
    ds_read_b64_tr_b16 v[234:235], v20 offset:10240
    v_add_f32 v23, v23, v180
    v_add_f32 v9, v9, v181
    v_add_f32 v23, v23, v182
    v_add_f32 v9, v9, v183
    v_cvt_pk_bf16_f32 v176, v176, v177
    v_mfma_f32_32x32x16_bf16 v[80:95], v[236:239], v[168:171], v[80:95]
    ds_read_b64_tr_b16 v[236:237], v21 offset:8192
    ds_read_b64_tr_b16 v[238:239], v21 offset:10240
    v_cvt_pk_bf16_f32 v177, v178, v179
    v_cvt_pk_bf16_f32 v178, v180, v181
    v_cvt_pk_bf16_f32 v179, v182, v183
    v_fma_f32 v184, v184, s34, -v24
    v_fma_f32 v185, v185, s34, -v24
    s_waitcnt lgkmcnt(8)
    v_mfma_f32_32x32x16_bf16 v[96:111], v[216:219], v[168:171], v[96:111]
    ds_read_b64_tr_b16 v[216:217], v18 offset:12288
    ds_read_b64_tr_b16 v[218:219], v18 offset:14336
    v_fma_f32 v186, v186, s34, -v24
    v_fma_f32 v187, v187, s34, -v24
    v_fma_f32 v188, v188, s34, -v24
    v_fma_f32 v189, v189, s34, -v24
    v_fma_f32 v190, v190, s34, -v24
    v_mfma_f32_32x32x16_bf16 v[112:127], v[220:223], v[168:171], v[112:127]
    ds_read_b64_tr_b16 v[220:221], v19 offset:12288
    ds_read_b64_tr_b16 v[222:223], v19 offset:14336
    v_fma_f32 v191, v191, s34, -v24
    v_exp_f32 v184, v184
    v_exp_f32 v185, v185
    v_exp_f32 v186, v186
    v_exp_f32 v187, v187
    s_waitcnt lgkmcnt(8)
    v_mfma_f32_32x32x16_bf16 v[64:79], v[224:227], v[176:179], v[64:79]
    ds_read_b64_tr_b16 v[224:225], v20 offset:12288
    ds_read_b64_tr_b16 v[226:227], v20 offset:14336
    v_exp_f32 v188, v188
    v_exp_f32 v189, v189
    v_exp_f32 v190, v190
    v_exp_f32 v191, v191
    v_add_f32 v23, v23, v184
    v_mfma_f32_32x32x16_bf16 v[80:95], v[228:231], v[176:179], v[80:95]
    ds_read_b64_tr_b16 v[228:229], v21 offset:12288
    ds_read_b64_tr_b16 v[230:231], v21 offset:14336
    v_add_f32 v9, v9, v185
    v_add_f32 v23, v23, v186
    v_add_f32 v9, v9, v187
    v_add_f32 v23, v23, v188
    v_add_f32 v9, v9, v189
    s_waitcnt lgkmcnt(8)
    v_mfma_f32_32x32x16_bf16 v[96:111], v[232:235], v[176:179], v[96:111]
    v_add_f32 v23, v23, v190
    v_add_f32 v9, v9, v191
    v_cvt_pk_bf16_f32 v184, v184, v185
    v_cvt_pk_bf16_f32 v185, v186, v187
    v_cvt_pk_bf16_f32 v186, v188, v189
    v_cvt_pk_bf16_f32 v187, v190, v191
    v_mfma_f32_32x32x16_bf16 v[112:127], v[236:239], v[176:179], v[112:127]
    s_waitcnt lgkmcnt(4)
    v_mfma_f32_32x32x16_bf16 v[64:79], v[216:219], v[184:187], v[64:79]
    v_mfma_f32_32x32x16_bf16 v[80:95], v[220:223], v[184:187], v[80:95]
    s_waitcnt lgkmcnt(0)
    v_mfma_f32_32x32x16_bf16 v[96:111], v[224:227], v[184:187], v[96:111]
    v_mfma_f32_32x32x16_bf16 v[112:127], v[228:231], v[184:187], v[112:127]
    s_barrier
    v_add_u32 v10, 147456, v28
    v_xor_b32 v11, 32, v10
    v_xor_b32 v12, 64, v10
    v_xor_b32 v13, 96, v10
    v_xor_b32 v14, 128, v10
    v_xor_b32 v15, 160, v10
    v_xor_b32 v16, 192, v10
    v_xor_b32 v17, 224, v10
    ds_read_b128 v[192:195], v10 offset:0
    ds_read_b128 v[196:199], v11 offset:0
    ds_read_b128 v[200:203], v12 offset:0
    ds_read_b128 v[204:207], v13 offset:0
    ds_read_b128 v[208:211], v14 offset:0
    ds_read_b128 v[212:215], v15 offset:0
    v_add_u32 v18, 0, v29
    v_xor_b32 v19, 64, v18
    v_xor_b32 v20, 128, v18
    v_xor_b32 v21, 192, v18
    v_max3_f32 v26, v128, v129, v130
    v_max3_f32 v27, v144, v145, v146
    v_max3_f32 v26, v26, v131, v132
    v_max3_f32 v27, v27, v147, v148
    v_max3_f32 v26, v26, v133, v134
    v_max3_f32 v27, v27, v149, v150
    v_max3_f32 v26, v26, v135, v136
    v_max3_f32 v27, v27, v151, v152
    v_max3_f32 v26, v26, v137, v138
    v_max3_f32 v27, v27, v153, v154
    v_max3_f32 v26, v26, v139, v140
    v_max3_f32 v27, v27, v155, v156
    v_max3_f32 v26, v26, v141, v142
    v_max3_f32 v27, v27, v157, v158
    v_max_f32 v26, v26, v143
    v_max_f32 v27, v27, v159
    s_waitcnt lgkmcnt(4)
    v_mfma_f32_32x32x16_bf16 v[160:175], v[192:195], v[32:35], 0
    ds_read_b128 v[192:195], v16 offset:0
    v_max_f32 v26, v26, v27
    v_mov_b32 v27, v26
    s_nop 1
    v_permlane32_swap_b32 v26, v27
    v_mfma_f32_32x32x16_bf16 v[160:175], v[196:199], v[36:39], v[160:175]
    ds_read_b128 v[196:199], v17 offset:0
    v_max_f32 v26, v26, v27
    v_sub_f32 v27, v26, v22
    v_cmp_lt_f32 vcc, s61, v27
    s_nop 4
    s_cbranch_vccz attn_kernel_lz22
    v_max_f32 v26, v26, v22
    v_sub_f32 v27, v22, v26
    v_mul_f32 v27, s34, v27
    v_exp_f32 v25, v27
    v_mov_b32 v22, v26
    v_mul_f32 v24, s34, v26
    v_mul_f32 v23, v23, v25
    v_mul_f32 v9, v9, v25
    s_nop 11
    v_mul_f32 v64, v64, v25
    v_mul_f32 v65, v65, v25
    v_mul_f32 v66, v66, v25
    v_mul_f32 v67, v67, v25
    v_mul_f32 v68, v68, v25
    v_mul_f32 v69, v69, v25
    v_mul_f32 v70, v70, v25
    v_mul_f32 v71, v71, v25
    v_mul_f32 v72, v72, v25
    v_mul_f32 v73, v73, v25
    v_mul_f32 v74, v74, v25
    v_mul_f32 v75, v75, v25
    v_mul_f32 v76, v76, v25
    v_mul_f32 v77, v77, v25
    v_mul_f32 v78, v78, v25
    v_mul_f32 v79, v79, v25
    v_mul_f32 v80, v80, v25
    v_mul_f32 v81, v81, v25
    v_mul_f32 v82, v82, v25
    v_mul_f32 v83, v83, v25
    v_mul_f32 v84, v84, v25
    v_mul_f32 v85, v85, v25
    v_mul_f32 v86, v86, v25
    v_mul_f32 v87, v87, v25
    v_mul_f32 v88, v88, v25
    v_mul_f32 v89, v89, v25
    v_mul_f32 v90, v90, v25
    v_mul_f32 v91, v91, v25
    v_mul_f32 v92, v92, v25
    v_mul_f32 v93, v93, v25
    v_mul_f32 v94, v94, v25
    v_mul_f32 v95, v95, v25
    v_mul_f32 v96, v96, v25
    v_mul_f32 v97, v97, v25
    v_mul_f32 v98, v98, v25
    v_mul_f32 v99, v99, v25
    v_mul_f32 v100, v100, v25
    v_mul_f32 v101, v101, v25
    v_mul_f32 v102, v102, v25
    v_mul_f32 v103, v103, v25
    v_mul_f32 v104, v104, v25
    v_mul_f32 v105, v105, v25
    v_mul_f32 v106, v106, v25
    v_mul_f32 v107, v107, v25
    v_mul_f32 v108, v108, v25
    v_mul_f32 v109, v109, v25
    v_mul_f32 v110, v110, v25
    v_mul_f32 v111, v111, v25
    v_mul_f32 v112, v112, v25
    v_mul_f32 v113, v113, v25
    v_mul_f32 v114, v114, v25
    v_mul_f32 v115, v115, v25
    v_mul_f32 v116, v116, v25
    v_mul_f32 v117, v117, v25
    v_mul_f32 v118, v118, v25
    v_mul_f32 v119, v119, v25
    v_mul_f32 v120, v120, v25
    v_mul_f32 v121, v121, v25
    v_mul_f32 v122, v122, v25
    v_mul_f32 v123, v123, v25
    v_mul_f32 v124, v124, v25
    v_mul_f32 v125, v125, v25
    v_mul_f32 v126, v126, v25
    v_mul_f32 v127, v127, v25
    s_nop 1
attn_kernel_lz22:
    v_fma_f32 v128, v128, s34, -v24
    s_waitcnt lgkmcnt(4)
    v_mfma_f32_32x32x16_bf16 v[160:175], v[200:203], v[40:43], v[160:175]
    ds_read_b128 v[200:203], v10 offset:8192
    v_fma_f32 v129, v129, s34, -v24
    v_fma_f32 v130, v130, s34, -v24
    v_fma_f32 v131, v131, s34, -v24
    v_fma_f32 v132, v132, s34, -v24
    v_mfma_f32_32x32x16_bf16 v[160:175], v[204:207], v[44:47], v[160:175]
    ds_read_b128 v[204:207], v11 offset:8192
    v_fma_f32 v133, v133, s34, -v24
    v_fma_f32 v134, v134, s34, -v24
    v_fma_f32 v135, v135, s34, -v24
    v_exp_f32 v128, v128
    s_waitcnt lgkmcnt(4)
    v_mfma_f32_32x32x16_bf16 v[160:175], v[208:211], v[48:51], v[160:175]
    ds_read_b128 v[208:211], v12 offset:8192
    v_exp_f32 v129, v129
    v_exp_f32 v130, v130
    v_exp_f32 v131, v131
    v_exp_f32 v132, v132
    v_mfma_f32_32x32x16_bf16 v[160:175], v[212:215], v[52:55], v[160:175]
    ds_read_b128 v[212:215], v13 offset:8192
    v_exp_f32 v133, v133
    v_exp_f32 v134, v134
    v_exp_f32 v135, v135
    v_add_f32 v23, v23, v128
    s_waitcnt lgkmcnt(4)
    v_mfma_f32_32x32x16_bf16 v[160:175], v[192:195], v[56:59], v[160:175]
    ds_read_b128 v[192:195], v14 offset:8192
    v_add_f32 v9, v9, v129
    v_add_f32 v23, v23, v130
    v_add_f32 v9, v9, v131
    v_add_f32 v23, v23, v132
    v_mfma_f32_32x32x16_bf16 v[160:175], v[196:199], v[60:63], v[160:175]
    ds_read_b128 v[196:199], v15 offset:8192
    v_add_f32 v9, v9, v133
    v_add_f32 v23, v23, v134
    v_add_f32 v9, v9, v135
    v_cvt_pk_bf16_f32 v128, v128, v129
    s_waitcnt lgkmcnt(4)
    v_mfma_f32_32x32x16_bf16 v[176:191], v[200:203], v[32:35], 0
    ds_read_b128 v[200:203], v16 offset:8192
    v_cvt_pk_bf16_f32 v129, v130, v131
    v_cvt_pk_bf16_f32 v130, v132, v133
    v_cvt_pk_bf16_f32 v131, v134, v135
    v_mfma_f32_32x32x16_bf16 v[176:191], v[204:207], v[36:39], v[176:191]
    ds_read_b128 v[204:207], v17 offset:8192
    v_fma_f32 v136, v136, s34, -v24
    v_fma_f32 v137, v137, s34, -v24
    v_fma_f32 v138, v138, s34, -v24
    v_fma_f32 v139, v139, s34, -v24
    s_waitcnt lgkmcnt(4)
    v_mfma_f32_32x32x16_bf16 v[176:191], v[208:211], v[40:43], v[176:191]
    ds_read_b64_tr_b16 v[216:217], v18 offset:0
    ds_read_b64_tr_b16 v[218:219], v18 offset:2048
    v_fma_f32 v140, v140, s34, -v24
    v_fma_f32 v141, v141, s34, -v24
    v_fma_f32 v142, v142, s34, -v24
    v_fma_f32 v143, v143, s34, -v24
    v_mfma_f32_32x32x16_bf16 v[176:191], v[212:215], v[44:47], v[176:191]
    ds_read_b64_tr_b16 v[220:221], v19 offset:0
    ds_read_b64_tr_b16 v[222:223], v19 offset:2048
    v_exp_f32 v136, v136
    v_exp_f32 v137, v137
    v_exp_f32 v138, v138
    v_exp_f32 v139, v139
    s_waitcnt lgkmcnt(6)
    v_mfma_f32_32x32x16_bf16 v[176:191], v[192:195], v[48:51], v[176:191]
    ds_read_b64_tr_b16 v[224:225], v20 offset:0
    ds_read_b64_tr_b16 v[226:227], v20 offset:2048
    v_exp_f32 v140, v140
    v_exp_f32 v141, v141
    v_exp_f32 v142, v142
    v_exp_f32 v143, v143
    v_mfma_f32_32x32x16_bf16 v[176:191], v[196:199], v[52:55], v[176:191]
    ds_read_b64_tr_b16 v[228:229], v21 offset:0
    ds_read_b64_tr_b16 v[230:231], v21 offset:2048
    v_add_f32 v23, v23, v136
    v_add_f32 v9, v9, v137
    v_add_f32 v23, v23, v138
    v_add_f32 v9, v9, v139
    s_waitcnt lgkmcnt(8)
    v_mfma_f32_32x32x16_bf16 v[176:191], v[200:203], v[56:59], v[176:191]
    ds_read_b64_tr_b16 v[232:233], v18 offset:4096
    ds_read_b64_tr_b16 v[234:235], v18 offset:6144
    v_add_f32 v23, v23, v140
    v_add_f32 v9, v9, v141
    v_add_f32 v23, v23, v142
    v_add_f32 v9, v9, v143
    v_mfma_f32_32x32x16_bf16 v[176:191], v[204:207], v[60:63], v[176:191]
    ds_read_b64_tr_b16 v[236:237], v19 offset:4096
    ds_read_b64_tr_b16 v[238:239], v19 offset:6144
    v_cvt_pk_bf16_f32 v136, v136, v137
    v_cvt_pk_bf16_f32 v137, v138, v139
    v_cvt_pk_bf16_f32 v138, v140, v141
    v_cvt_pk_bf16_f32 v139, v142, v143
    s_waitcnt lgkmcnt(8)
    v_mfma_f32_32x32x16_bf16 v[64:79], v[216:219], v[128:131], v[64:79]
    ds_read_b64_tr_b16 v[216:217], v20 offset:4096
    ds_read_b64_tr_b16 v[218:219], v20 offset:6144
    v_fma_f32 v144, v144, s34, -v24
    v_fma_f32 v145, v145, s34, -v24
    v_fma_f32 v146, v146, s34, -v24
    v_fma_f32 v147, v147, s34, -v24
    v_fma_f32 v148, v148, s34, -v24
    v_mfma_f32_32x32x16_bf16 v[80:95], v[220:223], v[128:131], v[80:95]
    ds_read_b64_tr_b16 v[220:221], v21 offset:4096
    ds_read_b64_tr_b16 v[222:223], v21 offset:6144
    v_fma_f32 v149, v149, s34, -v24
    v_fma_f32 v150, v150, s34, -v24
    v_fma_f32 v151, v151, s34, -v24
    v_exp_f32 v144, v144
    v_exp_f32 v145, v145
    s_waitcnt lgkmcnt(8)
    v_mfma_f32_32x32x16_bf16 v[96:111], v[224:227], v[128:131], v[96:111]
    ds_read_b64_tr_b16 v[224:225], v18 offset:8192
    ds_read_b64_tr_b16 v[226:227], v18 offset:10240
    v_exp_f32 v146, v146
    v_exp_f32 v147, v147
    v_exp_f32 v148, v148
    v_exp_f32 v149, v149
    v_exp_f32 v150, v150
    v_mfma_f32_32x32x16_bf16 v[112:127], v[228:231], v[128:131], v[112:127]
    ds_read_b64_tr_b16 v[228:229], v19 offset:8192
    ds_read_b64_tr_b16 v[230:231], v19 offset:10240
    v_exp_f32 v151, v151
    v_add_f32 v23, v23, v144
    v_add_f32 v9, v9, v145
    v_add_f32 v23, v23, v146
    v_add_f32 v9, v9, v147
    s_waitcnt lgkmcnt(8)
    v_mfma_f32_32x32x16_bf16 v[64:79], v[232:235], v[136:139], v[64:79]
    ds_read_b64_tr_b16 v[232:233], v20 offset:8192
    ds_read_b64_tr_b16 v[234:235], v20 offset:10240
    v_add_f32 v23, v23, v148
    v_add_f32 v9, v9, v149
    v_add_f32 v23, v23, v150
    v_add_f32 v9, v9, v151
    v_cvt_pk_bf16_f32 v144, v144, v145
    v_mfma_f32_32x32x16_bf16 v[80:95], v[236:239], v[136:139], v[80:95]
    ds_read_b64_tr_b16 v[236:237], v21 offset:8192
    ds_read_b64_tr_b16 v[238:239], v21 offset:10240
    v_cvt_pk_bf16_f32 v145, v146, v147
    v_cvt_pk_bf16_f32 v146, v148, v149
    v_cvt_pk_bf16_f32 v147, v150, v151
    v_fma_f32 v152, v152, s34, -v24
    v_fma_f32 v153, v153, s34, -v24
    s_waitcnt lgkmcnt(8)
    v_mfma_f32_32x32x16_bf16 v[96:111], v[216:219], v[136:139], v[96:111]
    ds_read_b64_tr_b16 v[216:217], v18 offset:12288
    ds_read_b64_tr_b16 v[218:219], v18 offset:14336
    v_fma_f32 v154, v154, s34, -v24
    v_fma_f32 v155, v155, s34, -v24
    v_fma_f32 v156, v156, s34, -v24
    v_fma_f32 v157, v157, s34, -v24
    v_fma_f32 v158, v158, s34, -v24
    v_mfma_f32_32x32x16_bf16 v[112:127], v[220:223], v[136:139], v[112:127]
    ds_read_b64_tr_b16 v[220:221], v19 offset:12288
    ds_read_b64_tr_b16 v[222:223], v19 offset:14336
    v_fma_f32 v159, v159, s34, -v24
    v_exp_f32 v152, v152
    v_exp_f32 v153, v153
    v_exp_f32 v154, v154
    v_exp_f32 v155, v155
    s_waitcnt lgkmcnt(8)
    v_mfma_f32_32x32x16_bf16 v[64:79], v[224:227], v[144:147], v[64:79]
    ds_read_b64_tr_b16 v[224:225], v20 offset:12288
    ds_read_b64_tr_b16 v[226:227], v20 offset:14336
    v_exp_f32 v156, v156
    v_exp_f32 v157, v157
    v_exp_f32 v158, v158
    v_exp_f32 v159, v159
    v_add_f32 v23, v23, v152
    v_mfma_f32_32x32x16_bf16 v[80:95], v[228:231], v[144:147], v[80:95]
    ds_read_b64_tr_b16 v[228:229], v21 offset:12288
    ds_read_b64_tr_b16 v[230:231], v21 offset:14336
    v_add_f32 v9, v9, v153
    v_add_f32 v23, v23, v154
    v_add_f32 v9, v9, v155
    v_add_f32 v23, v23, v156
    v_add_f32 v9, v9, v157
    s_waitcnt lgkmcnt(8)
    v_mfma_f32_32x32x16_bf16 v[96:111], v[232:235], v[144:147], v[96:111]
    v_add_f32 v23, v23, v158
    v_add_f32 v9, v9, v159
    v_cvt_pk_bf16_f32 v152, v152, v153
    v_cvt_pk_bf16_f32 v153, v154, v155
    v_cvt_pk_bf16_f32 v154, v156, v157
    v_cvt_pk_bf16_f32 v155, v158, v159
    v_mfma_f32_32x32x16_bf16 v[112:127], v[236:239], v[144:147], v[112:127]
    s_waitcnt lgkmcnt(4)
    v_mfma_f32_32x32x16_bf16 v[64:79], v[216:219], v[152:155], v[64:79]
    v_mfma_f32_32x32x16_bf16 v[80:95], v[220:223], v[152:155], v[80:95]
    s_waitcnt lgkmcnt(0)
    v_mfma_f32_32x32x16_bf16 v[96:111], v[224:227], v[152:155], v[96:111]
    v_mfma_f32_32x32x16_bf16 v[112:127], v[228:231], v[152:155], v[112:127]
    s_barrier
    v_add_u32 v10, 16384, v28
    v_xor_b32 v11, 32, v10
    v_xor_b32 v12, 64, v10
    v_xor_b32 v13, 96, v10
    v_xor_b32 v14, 128, v10
    v_xor_b32 v15, 160, v10
    v_xor_b32 v16, 192, v10
    v_xor_b32 v17, 224, v10
    ds_read_b128 v[192:195], v10 offset:0
    ds_read_b128 v[196:199], v11 offset:0
    ds_read_b128 v[200:203], v12 offset:0
    ds_read_b128 v[204:207], v13 offset:0
    ds_read_b128 v[208:211], v14 offset:0
    ds_read_b128 v[212:215], v15 offset:0
    v_add_u32 v18, 32768, v29
    v_xor_b32 v19, 64, v18
    v_xor_b32 v20, 128, v18
    v_xor_b32 v21, 192, v18
    v_max3_f32 v26, v160, v161, v162
    v_max3_f32 v27, v176, v177, v178
    v_max3_f32 v26, v26, v163, v164
    v_max3_f32 v27, v27, v179, v180
    v_max3_f32 v26, v26, v165, v166
    v_max3_f32 v27, v27, v181, v182
    v_max3_f32 v26, v26, v167, v168
    v_max3_f32 v27, v27, v183, v184
    v_max3_f32 v26, v26, v169, v170
    v_max3_f32 v27, v27, v185, v186
    v_max3_f32 v26, v26, v171, v172
    v_max3_f32 v27, v27, v187, v188
    v_max3_f32 v26, v26, v173, v174
    v_max3_f32 v27, v27, v189, v190
    v_max_f32 v26, v26, v175
    v_max_f32 v27, v27, v191
    s_waitcnt lgkmcnt(4)
    v_mfma_f32_32x32x16_bf16 v[128:143], v[192:195], v[32:35], 0
    ds_read_b128 v[192:195], v16 offset:0
    v_max_f32 v26, v26, v27
    v_mov_b32 v27, v26
    s_nop 1
    v_permlane32_swap_b32 v26, v27
    v_mfma_f32_32x32x16_bf16 v[128:143], v[196:199], v[36:39], v[128:143]
    ds_read_b128 v[196:199], v17 offset:0
    v_max_f32 v26, v26, v27
    v_sub_f32 v27, v26, v22
    v_cmp_lt_f32 vcc, s61, v27
    s_nop 4
    s_cbranch_vccz attn_kernel_lz23
    v_max_f32 v26, v26, v22
    v_sub_f32 v27, v22, v26
    v_mul_f32 v27, s34, v27
    v_exp_f32 v25, v27
    v_mov_b32 v22, v26
    v_mul_f32 v24, s34, v26
    v_mul_f32 v23, v23, v25
    v_mul_f32 v9, v9, v25
    s_nop 11
    v_mul_f32 v64, v64, v25
    v_mul_f32 v65, v65, v25
    v_mul_f32 v66, v66, v25
    v_mul_f32 v67, v67, v25
    v_mul_f32 v68, v68, v25
    v_mul_f32 v69, v69, v25
    v_mul_f32 v70, v70, v25
    v_mul_f32 v71, v71, v25
    v_mul_f32 v72, v72, v25
    v_mul_f32 v73, v73, v25
    v_mul_f32 v74, v74, v25
    v_mul_f32 v75, v75, v25
    v_mul_f32 v76, v76, v25
    v_mul_f32 v77, v77, v25
    v_mul_f32 v78, v78, v25
    v_mul_f32 v79, v79, v25
    v_mul_f32 v80, v80, v25
    v_mul_f32 v81, v81, v25
    v_mul_f32 v82, v82, v25
    v_mul_f32 v83, v83, v25
    v_mul_f32 v84, v84, v25
    v_mul_f32 v85, v85, v25
    v_mul_f32 v86, v86, v25
    v_mul_f32 v87, v87, v25
    v_mul_f32 v88, v88, v25
    v_mul_f32 v89, v89, v25
    v_mul_f32 v90, v90, v25
    v_mul_f32 v91, v91, v25
    v_mul_f32 v92, v92, v25
    v_mul_f32 v93, v93, v25
    v_mul_f32 v94, v94, v25
    v_mul_f32 v95, v95, v25
    v_mul_f32 v96, v96, v25
    v_mul_f32 v97, v97, v25
    v_mul_f32 v98, v98, v25
    v_mul_f32 v99, v99, v25
    v_mul_f32 v100, v100, v25
    v_mul_f32 v101, v101, v25
    v_mul_f32 v102, v102, v25
    v_mul_f32 v103, v103, v25
    v_mul_f32 v104, v104, v25
    v_mul_f32 v105, v105, v25
    v_mul_f32 v106, v106, v25
    v_mul_f32 v107, v107, v25
    v_mul_f32 v108, v108, v25
    v_mul_f32 v109, v109, v25
    v_mul_f32 v110, v110, v25
    v_mul_f32 v111, v111, v25
    v_mul_f32 v112, v112, v25
    v_mul_f32 v113, v113, v25
    v_mul_f32 v114, v114, v25
    v_mul_f32 v115, v115, v25
    v_mul_f32 v116, v116, v25
    v_mul_f32 v117, v117, v25
    v_mul_f32 v118, v118, v25
    v_mul_f32 v119, v119, v25
    v_mul_f32 v120, v120, v25
    v_mul_f32 v121, v121, v25
    v_mul_f32 v122, v122, v25
    v_mul_f32 v123, v123, v25
    v_mul_f32 v124, v124, v25
    v_mul_f32 v125, v125, v25
    v_mul_f32 v126, v126, v25
    v_mul_f32 v127, v127, v25
    s_nop 1
attn_kernel_lz23:
    v_fma_f32 v160, v160, s34, -v24
    s_waitcnt lgkmcnt(4)
    v_mfma_f32_32x32x16_bf16 v[128:143], v[200:203], v[40:43], v[128:143]
    ds_read_b128 v[200:203], v10 offset:8192
    v_fma_f32 v161, v161, s34, -v24
    v_fma_f32 v162, v162, s34, -v24
    v_fma_f32 v163, v163, s34, -v24
    v_fma_f32 v164, v164, s34, -v24
    v_mfma_f32_32x32x16_bf16 v[128:143], v[204:207], v[44:47], v[128:143]
    ds_read_b128 v[204:207], v11 offset:8192
    v_fma_f32 v165, v165, s34, -v24
    v_fma_f32 v166, v166, s34, -v24
    v_fma_f32 v167, v167, s34, -v24
    v_exp_f32 v160, v160
    s_waitcnt lgkmcnt(4)
    v_mfma_f32_32x32x16_bf16 v[128:143], v[208:211], v[48:51], v[128:143]
    ds_read_b128 v[208:211], v12 offset:8192
    v_exp_f32 v161, v161
    v_exp_f32 v162, v162
    v_exp_f32 v163, v163
    v_exp_f32 v164, v164
    v_mfma_f32_32x32x16_bf16 v[128:143], v[212:215], v[52:55], v[128:143]
    ds_read_b128 v[212:215], v13 offset:8192
    v_exp_f32 v165, v165
    v_exp_f32 v166, v166
    v_exp_f32 v167, v167
    v_add_f32 v23, v23, v160
    s_waitcnt lgkmcnt(4)
    v_mfma_f32_32x32x16_bf16 v[128:143], v[192:195], v[56:59], v[128:143]
    ds_read_b128 v[192:195], v14 offset:8192
    v_add_f32 v9, v9, v161
    v_add_f32 v23, v23, v162
    v_add_f32 v9, v9, v163
    v_add_f32 v23, v23, v164
    v_mfma_f32_32x32x16_bf16 v[128:143], v[196:199], v[60:63], v[128:143]
    ds_read_b128 v[196:199], v15 offset:8192
    v_add_f32 v9, v9, v165
    v_add_f32 v23, v23, v166
    v_add_f32 v9, v9, v167
    v_cvt_pk_bf16_f32 v160, v160, v161
    s_waitcnt lgkmcnt(4)
    v_mfma_f32_32x32x16_bf16 v[144:159], v[200:203], v[32:35], 0
    ds_read_b128 v[200:203], v16 offset:8192
    v_cvt_pk_bf16_f32 v161, v162, v163
    v_cvt_pk_bf16_f32 v162, v164, v165
    v_cvt_pk_bf16_f32 v163, v166, v167
    v_mfma_f32_32x32x16_bf16 v[144:159], v[204:207], v[36:39], v[144:159]
    ds_read_b128 v[204:207], v17 offset:8192
    v_fma_f32 v168, v168, s34, -v24
    v_fma_f32 v169, v169, s34, -v24
    v_fma_f32 v170, v170, s34, -v24
    v_fma_f32 v171, v171, s34, -v24
    s_waitcnt lgkmcnt(4)
    v_mfma_f32_32x32x16_bf16 v[144:159], v[208:211], v[40:43], v[144:159]
    ds_read_b64_tr_b16 v[216:217], v18 offset:0
    ds_read_b64_tr_b16 v[218:219], v18 offset:2048
    v_fma_f32 v172, v172, s34, -v24
    v_fma_f32 v173, v173, s34, -v24
    v_fma_f32 v174, v174, s34, -v24
    v_fma_f32 v175, v175, s34, -v24
    v_mfma_f32_32x32x16_bf16 v[144:159], v[212:215], v[44:47], v[144:159]
    ds_read_b64_tr_b16 v[220:221], v19 offset:0
    ds_read_b64_tr_b16 v[222:223], v19 offset:2048
    v_exp_f32 v168, v168
    v_exp_f32 v169, v169
    v_exp_f32 v170, v170
    v_exp_f32 v171, v171
    s_waitcnt lgkmcnt(6)
    v_mfma_f32_32x32x16_bf16 v[144:159], v[192:195], v[48:51], v[144:159]
    ds_read_b64_tr_b16 v[224:225], v20 offset:0
    ds_read_b64_tr_b16 v[226:227], v20 offset:2048
    v_exp_f32 v172, v172
    v_exp_f32 v173, v173
    v_exp_f32 v174, v174
    v_exp_f32 v175, v175
    v_mfma_f32_32x32x16_bf16 v[144:159], v[196:199], v[52:55], v[144:159]
    ds_read_b64_tr_b16 v[228:229], v21 offset:0
    ds_read_b64_tr_b16 v[230:231], v21 offset:2048
    v_add_f32 v23, v23, v168
    v_add_f32 v9, v9, v169
    v_add_f32 v23, v23, v170
    v_add_f32 v9, v9, v171
    s_waitcnt lgkmcnt(8)
    v_mfma_f32_32x32x16_bf16 v[144:159], v[200:203], v[56:59], v[144:159]
    ds_read_b64_tr_b16 v[232:233], v18 offset:4096
    ds_read_b64_tr_b16 v[234:235], v18 offset:6144
    v_add_f32 v23, v23, v172
    v_add_f32 v9, v9, v173
    v_add_f32 v23, v23, v174
    v_add_f32 v9, v9, v175
    v_mfma_f32_32x32x16_bf16 v[144:159], v[204:207], v[60:63], v[144:159]
    ds_read_b64_tr_b16 v[236:237], v19 offset:4096
    ds_read_b64_tr_b16 v[238:239], v19 offset:6144
    v_cvt_pk_bf16_f32 v168, v168, v169
    v_cvt_pk_bf16_f32 v169, v170, v171
    v_cvt_pk_bf16_f32 v170, v172, v173
    v_cvt_pk_bf16_f32 v171, v174, v175
    s_waitcnt lgkmcnt(8)
    v_mfma_f32_32x32x16_bf16 v[64:79], v[216:219], v[160:163], v[64:79]
    ds_read_b64_tr_b16 v[216:217], v20 offset:4096
    ds_read_b64_tr_b16 v[218:219], v20 offset:6144
    v_fma_f32 v176, v176, s34, -v24
    v_fma_f32 v177, v177, s34, -v24
    v_fma_f32 v178, v178, s34, -v24
    v_fma_f32 v179, v179, s34, -v24
    v_fma_f32 v180, v180, s34, -v24
    v_mfma_f32_32x32x16_bf16 v[80:95], v[220:223], v[160:163], v[80:95]
    ds_read_b64_tr_b16 v[220:221], v21 offset:4096
    ds_read_b64_tr_b16 v[222:223], v21 offset:6144
    v_fma_f32 v181, v181, s34, -v24
    v_fma_f32 v182, v182, s34, -v24
    v_fma_f32 v183, v183, s34, -v24
    v_exp_f32 v176, v176
    v_exp_f32 v177, v177
    s_waitcnt lgkmcnt(8)
    v_mfma_f32_32x32x16_bf16 v[96:111], v[224:227], v[160:163], v[96:111]
    ds_read_b64_tr_b16 v[224:225], v18 offset:8192
    ds_read_b64_tr_b16 v[226:227], v18 offset:10240
    v_exp_f32 v178, v178
    v_exp_f32 v179, v179
    v_exp_f32 v180, v180
    v_exp_f32 v181, v181
    v_exp_f32 v182, v182
    v_mfma_f32_32x32x16_bf16 v[112:127], v[228:231], v[160:163], v[112:127]
    ds_read_b64_tr_b16 v[228:229], v19 offset:8192
    ds_read_b64_tr_b16 v[230:231], v19 offset:10240
    v_exp_f32 v183, v183
    v_add_f32 v23, v23, v176
    v_add_f32 v9, v9, v177
    v_add_f32 v23, v23, v178
    v_add_f32 v9, v9, v179
    s_waitcnt lgkmcnt(8)
    v_mfma_f32_32x32x16_bf16 v[64:79], v[232:235], v[168:171], v[64:79]
    ds_read_b64_tr_b16 v[232:233], v20 offset:8192
    ds_read_b64_tr_b16 v[234:235], v20 offset:10240
    v_add_f32 v23, v23, v180
    v_add_f32 v9, v9, v181
    v_add_f32 v23, v23, v182
    v_add_f32 v9, v9, v183
    v_cvt_pk_bf16_f32 v176, v176, v177
    v_mfma_f32_32x32x16_bf16 v[80:95], v[236:239], v[168:171], v[80:95]
    ds_read_b64_tr_b16 v[236:237], v21 offset:8192
    ds_read_b64_tr_b16 v[238:239], v21 offset:10240
    v_cvt_pk_bf16_f32 v177, v178, v179
    v_cvt_pk_bf16_f32 v178, v180, v181
    v_cvt_pk_bf16_f32 v179, v182, v183
    v_fma_f32 v184, v184, s34, -v24
    v_fma_f32 v185, v185, s34, -v24
    s_waitcnt lgkmcnt(8)
    v_mfma_f32_32x32x16_bf16 v[96:111], v[216:219], v[168:171], v[96:111]
    ds_read_b64_tr_b16 v[216:217], v18 offset:12288
    ds_read_b64_tr_b16 v[218:219], v18 offset:14336
    v_fma_f32 v186, v186, s34, -v24
    v_fma_f32 v187, v187, s34, -v24
    v_fma_f32 v188, v188, s34, -v24
    v_fma_f32 v189, v189, s34, -v24
    v_fma_f32 v190, v190, s34, -v24
    v_mfma_f32_32x32x16_bf16 v[112:127], v[220:223], v[168:171], v[112:127]
    ds_read_b64_tr_b16 v[220:221], v19 offset:12288
    ds_read_b64_tr_b16 v[222:223], v19 offset:14336
    v_fma_f32 v191, v191, s34, -v24
    v_exp_f32 v184, v184
    v_exp_f32 v185, v185
    v_exp_f32 v186, v186
    v_exp_f32 v187, v187
    s_waitcnt lgkmcnt(8)
    v_mfma_f32_32x32x16_bf16 v[64:79], v[224:227], v[176:179], v[64:79]
    ds_read_b64_tr_b16 v[224:225], v20 offset:12288
    ds_read_b64_tr_b16 v[226:227], v20 offset:14336
    v_exp_f32 v188, v188
    v_exp_f32 v189, v189
    v_exp_f32 v190, v190
    v_exp_f32 v191, v191
    v_add_f32 v23, v23, v184
    v_mfma_f32_32x32x16_bf16 v[80:95], v[228:231], v[176:179], v[80:95]
    ds_read_b64_tr_b16 v[228:229], v21 offset:12288
    ds_read_b64_tr_b16 v[230:231], v21 offset:14336
    v_add_f32 v9, v9, v185
    v_add_f32 v23, v23, v186
    v_add_f32 v9, v9, v187
    v_add_f32 v23, v23, v188
    v_add_f32 v9, v9, v189
    s_waitcnt lgkmcnt(8)
    v_mfma_f32_32x32x16_bf16 v[96:111], v[232:235], v[176:179], v[96:111]
    v_add_f32 v23, v23, v190
    v_add_f32 v9, v9, v191
    v_cvt_pk_bf16_f32 v184, v184, v185
    v_cvt_pk_bf16_f32 v185, v186, v187
    v_cvt_pk_bf16_f32 v186, v188, v189
    v_cvt_pk_bf16_f32 v187, v190, v191
    v_mfma_f32_32x32x16_bf16 v[112:127], v[236:239], v[176:179], v[112:127]
    s_waitcnt lgkmcnt(4)
    v_mfma_f32_32x32x16_bf16 v[64:79], v[216:219], v[184:187], v[64:79]
    v_mfma_f32_32x32x16_bf16 v[80:95], v[220:223], v[184:187], v[80:95]
    s_waitcnt lgkmcnt(0)
    v_mfma_f32_32x32x16_bf16 v[96:111], v[224:227], v[184:187], v[96:111]
    v_mfma_f32_32x32x16_bf16 v[112:127], v[228:231], v[184:187], v[112:127]
    s_barrier
    v_add_u32 v10, 49152, v28
    v_xor_b32 v11, 32, v10
    v_xor_b32 v12, 64, v10
    v_xor_b32 v13, 96, v10
    v_xor_b32 v14, 128, v10
    v_xor_b32 v15, 160, v10
    v_xor_b32 v16, 192, v10
    v_xor_b32 v17, 224, v10
    ds_read_b128 v[192:195], v10 offset:0
    ds_read_b128 v[196:199], v11 offset:0
    ds_read_b128 v[200:203], v12 offset:0
    ds_read_b128 v[204:207], v13 offset:0
    ds_read_b128 v[208:211], v14 offset:0
    ds_read_b128 v[212:215], v15 offset:0
    v_add_u32 v18, 65536, v29
    v_xor_b32 v19, 64, v18
    v_xor_b32 v20, 128, v18
    v_xor_b32 v21, 192, v18
    v_max3_f32 v26, v128, v129, v130
    v_max3_f32 v27, v144, v145, v146
    v_max3_f32 v26, v26, v131, v132
    v_max3_f32 v27, v27, v147, v148
    v_max3_f32 v26, v26, v133, v134
    v_max3_f32 v27, v27, v149, v150
    v_max3_f32 v26, v26, v135, v136
    v_max3_f32 v27, v27, v151, v152
    v_max3_f32 v26, v26, v137, v138
    v_max3_f32 v27, v27, v153, v154
    v_max3_f32 v26, v26, v139, v140
    v_max3_f32 v27, v27, v155, v156
    v_max3_f32 v26, v26, v141, v142
    v_max3_f32 v27, v27, v157, v158
    v_max_f32 v26, v26, v143
    v_max_f32 v27, v27, v159
    s_waitcnt lgkmcnt(4)
    v_mfma_f32_32x32x16_bf16 v[160:175], v[192:195], v[32:35], 0
    ds_read_b128 v[192:195], v16 offset:0
    v_max_f32 v26, v26, v27
    v_mov_b32 v27, v26
    s_nop 1
    v_permlane32_swap_b32 v26, v27
    v_mfma_f32_32x32x16_bf16 v[160:175], v[196:199], v[36:39], v[160:175]
    ds_read_b128 v[196:199], v17 offset:0
    v_max_f32 v26, v26, v27
    v_sub_f32 v27, v26, v22
    v_cmp_lt_f32 vcc, s61, v27
    s_nop 4
    s_cbranch_vccz attn_kernel_lz24
    v_max_f32 v26, v26, v22
    v_sub_f32 v27, v22, v26
    v_mul_f32 v27, s34, v27
    v_exp_f32 v25, v27
    v_mov_b32 v22, v26
    v_mul_f32 v24, s34, v26
    v_mul_f32 v23, v23, v25
    v_mul_f32 v9, v9, v25
    s_nop 11
    v_mul_f32 v64, v64, v25
    v_mul_f32 v65, v65, v25
    v_mul_f32 v66, v66, v25
    v_mul_f32 v67, v67, v25
    v_mul_f32 v68, v68, v25
    v_mul_f32 v69, v69, v25
    v_mul_f32 v70, v70, v25
    v_mul_f32 v71, v71, v25
    v_mul_f32 v72, v72, v25
    v_mul_f32 v73, v73, v25
    v_mul_f32 v74, v74, v25
    v_mul_f32 v75, v75, v25
    v_mul_f32 v76, v76, v25
    v_mul_f32 v77, v77, v25
    v_mul_f32 v78, v78, v25
    v_mul_f32 v79, v79, v25
    v_mul_f32 v80, v80, v25
    v_mul_f32 v81, v81, v25
    v_mul_f32 v82, v82, v25
    v_mul_f32 v83, v83, v25
    v_mul_f32 v84, v84, v25
    v_mul_f32 v85, v85, v25
    v_mul_f32 v86, v86, v25
    v_mul_f32 v87, v87, v25
    v_mul_f32 v88, v88, v25
    v_mul_f32 v89, v89, v25
    v_mul_f32 v90, v90, v25
    v_mul_f32 v91, v91, v25
    v_mul_f32 v92, v92, v25
    v_mul_f32 v93, v93, v25
    v_mul_f32 v94, v94, v25
    v_mul_f32 v95, v95, v25
    v_mul_f32 v96, v96, v25
    v_mul_f32 v97, v97, v25
    v_mul_f32 v98, v98, v25
    v_mul_f32 v99, v99, v25
    v_mul_f32 v100, v100, v25
    v_mul_f32 v101, v101, v25
    v_mul_f32 v102, v102, v25
    v_mul_f32 v103, v103, v25
    v_mul_f32 v104, v104, v25
    v_mul_f32 v105, v105, v25
    v_mul_f32 v106, v106, v25
    v_mul_f32 v107, v107, v25
    v_mul_f32 v108, v108, v25
    v_mul_f32 v109, v109, v25
    v_mul_f32 v110, v110, v25
    v_mul_f32 v111, v111, v25
    v_mul_f32 v112, v112, v25
    v_mul_f32 v113, v113, v25
    v_mul_f32 v114, v114, v25
    v_mul_f32 v115, v115, v25
    v_mul_f32 v116, v116, v25
    v_mul_f32 v117, v117, v25
    v_mul_f32 v118, v118, v25
    v_mul_f32 v119, v119, v25
    v_mul_f32 v120, v120, v25
    v_mul_f32 v121, v121, v25
    v_mul_f32 v122, v122, v25
    v_mul_f32 v123, v123, v25
    v_mul_f32 v124, v124, v25
    v_mul_f32 v125, v125, v25
    v_mul_f32 v126, v126, v25
    v_mul_f32 v127, v127, v25
    s_nop 1
attn_kernel_lz24:
    v_fma_f32 v128, v128, s34, -v24
    s_waitcnt lgkmcnt(4)
    v_mfma_f32_32x32x16_bf16 v[160:175], v[200:203], v[40:43], v[160:175]
    ds_read_b128 v[200:203], v10 offset:8192
    v_fma_f32 v129, v129, s34, -v24
    v_fma_f32 v130, v130, s34, -v24
    v_fma_f32 v131, v131, s34, -v24
    v_fma_f32 v132, v132, s34, -v24
    v_mfma_f32_32x32x16_bf16 v[160:175], v[204:207], v[44:47], v[160:175]
    ds_read_b128 v[204:207], v11 offset:8192
    v_fma_f32 v133, v133, s34, -v24
    v_fma_f32 v134, v134, s34, -v24
    v_fma_f32 v135, v135, s34, -v24
    v_exp_f32 v128, v128
    s_waitcnt lgkmcnt(4)
    v_mfma_f32_32x32x16_bf16 v[160:175], v[208:211], v[48:51], v[160:175]
    ds_read_b128 v[208:211], v12 offset:8192
    v_exp_f32 v129, v129
    v_exp_f32 v130, v130
    v_exp_f32 v131, v131
    v_exp_f32 v132, v132
    v_mfma_f32_32x32x16_bf16 v[160:175], v[212:215], v[52:55], v[160:175]
    ds_read_b128 v[212:215], v13 offset:8192
    v_exp_f32 v133, v133
    v_exp_f32 v134, v134
    v_exp_f32 v135, v135
    v_add_f32 v23, v23, v128
    s_waitcnt lgkmcnt(4)
    v_mfma_f32_32x32x16_bf16 v[160:175], v[192:195], v[56:59], v[160:175]
    ds_read_b128 v[192:195], v14 offset:8192
    v_add_f32 v9, v9, v129
    v_add_f32 v23, v23, v130
    v_add_f32 v9, v9, v131
    v_add_f32 v23, v23, v132
    v_mfma_f32_32x32x16_bf16 v[160:175], v[196:199], v[60:63], v[160:175]
    ds_read_b128 v[196:199], v15 offset:8192
    v_add_f32 v9, v9, v133
    v_add_f32 v23, v23, v134
    v_add_f32 v9, v9, v135
    v_cvt_pk_bf16_f32 v128, v128, v129
    s_waitcnt lgkmcnt(4)
    v_mfma_f32_32x32x16_bf16 v[176:191], v[200:203], v[32:35], 0
    ds_read_b128 v[200:203], v16 offset:8192
    v_cvt_pk_bf16_f32 v129, v130, v131
    v_cvt_pk_bf16_f32 v130, v132, v133
    v_cvt_pk_bf16_f32 v131, v134, v135
    v_mfma_f32_32x32x16_bf16 v[176:191], v[204:207], v[36:39], v[176:191]
    ds_read_b128 v[204:207], v17 offset:8192
    v_fma_f32 v136, v136, s34, -v24
    v_fma_f32 v137, v137, s34, -v24
    v_fma_f32 v138, v138, s34, -v24
    v_fma_f32 v139, v139, s34, -v24
    s_waitcnt lgkmcnt(4)
    v_mfma_f32_32x32x16_bf16 v[176:191], v[208:211], v[40:43], v[176:191]
    ds_read_b64_tr_b16 v[216:217], v18 offset:0
    ds_read_b64_tr_b16 v[218:219], v18 offset:2048
    v_fma_f32 v140, v140, s34, -v24
    v_fma_f32 v141, v141, s34, -v24
    v_fma_f32 v142, v142, s34, -v24
    v_fma_f32 v143, v143, s34, -v24
    v_mfma_f32_32x32x16_bf16 v[176:191], v[212:215], v[44:47], v[176:191]
    ds_read_b64_tr_b16 v[220:221], v19 offset:0
    ds_read_b64_tr_b16 v[222:223], v19 offset:2048
    v_exp_f32 v136, v136
    v_exp_f32 v137, v137
    v_exp_f32 v138, v138
    v_exp_f32 v139, v139
    s_waitcnt lgkmcnt(6)
    v_mfma_f32_32x32x16_bf16 v[176:191], v[192:195], v[48:51], v[176:191]
    ds_read_b64_tr_b16 v[224:225], v20 offset:0
    ds_read_b64_tr_b16 v[226:227], v20 offset:2048
    v_exp_f32 v140, v140
    v_exp_f32 v141, v141
    v_exp_f32 v142, v142
    v_exp_f32 v143, v143
    v_mfma_f32_32x32x16_bf16 v[176:191], v[196:199], v[52:55], v[176:191]
    ds_read_b64_tr_b16 v[228:229], v21 offset:0
    ds_read_b64_tr_b16 v[230:231], v21 offset:2048
    v_add_f32 v23, v23, v136
    v_add_f32 v9, v9, v137
    v_add_f32 v23, v23, v138
    v_add_f32 v9, v9, v139
    s_waitcnt lgkmcnt(8)
    v_mfma_f32_32x32x16_bf16 v[176:191], v[200:203], v[56:59], v[176:191]
    ds_read_b64_tr_b16 v[232:233], v18 offset:4096
    ds_read_b64_tr_b16 v[234:235], v18 offset:6144
    v_add_f32 v23, v23, v140
    v_add_f32 v9, v9, v141
    v_add_f32 v23, v23, v142
    v_add_f32 v9, v9, v143
    v_mfma_f32_32x32x16_bf16 v[176:191], v[204:207], v[60:63], v[176:191]
    ds_read_b64_tr_b16 v[236:237], v19 offset:4096
    ds_read_b64_tr_b16 v[238:239], v19 offset:6144
    v_cvt_pk_bf16_f32 v136, v136, v137
    v_cvt_pk_bf16_f32 v137, v138, v139
    v_cvt_pk_bf16_f32 v138, v140, v141
    v_cvt_pk_bf16_f32 v139, v142, v143
    s_waitcnt lgkmcnt(8)
    v_mfma_f32_32x32x16_bf16 v[64:79], v[216:219], v[128:131], v[64:79]
    ds_read_b64_tr_b16 v[216:217], v20 offset:4096
    ds_read_b64_tr_b16 v[218:219], v20 offset:6144
    v_fma_f32 v144, v144, s34, -v24
    v_fma_f32 v145, v145, s34, -v24
    v_fma_f32 v146, v146, s34, -v24
    v_fma_f32 v147, v147, s34, -v24
    v_fma_f32 v148, v148, s34, -v24
    v_mfma_f32_32x32x16_bf16 v[80:95], v[220:223], v[128:131], v[80:95]
    ds_read_b64_tr_b16 v[220:221], v21 offset:4096
    ds_read_b64_tr_b16 v[222:223], v21 offset:6144
    v_fma_f32 v149, v149, s34, -v24
    v_fma_f32 v150, v150, s34, -v24
    v_fma_f32 v151, v151, s34, -v24
    v_exp_f32 v144, v144
    v_exp_f32 v145, v145
    s_waitcnt lgkmcnt(8)
    v_mfma_f32_32x32x16_bf16 v[96:111], v[224:227], v[128:131], v[96:111]
    ds_read_b64_tr_b16 v[224:225], v18 offset:8192
    ds_read_b64_tr_b16 v[226:227], v18 offset:10240
    v_exp_f32 v146, v146
    v_exp_f32 v147, v147
    v_exp_f32 v148, v148
    v_exp_f32 v149, v149
    v_exp_f32 v150, v150
    v_mfma_f32_32x32x16_bf16 v[112:127], v[228:231], v[128:131], v[112:127]
    ds_read_b64_tr_b16 v[228:229], v19 offset:8192
    ds_read_b64_tr_b16 v[230:231], v19 offset:10240
    v_exp_f32 v151, v151
    v_add_f32 v23, v23, v144
    v_add_f32 v9, v9, v145
    v_add_f32 v23, v23, v146
    v_add_f32 v9, v9, v147
    s_waitcnt lgkmcnt(8)
    v_mfma_f32_32x32x16_bf16 v[64:79], v[232:235], v[136:139], v[64:79]
    ds_read_b64_tr_b16 v[232:233], v20 offset:8192
    ds_read_b64_tr_b16 v[234:235], v20 offset:10240
    v_add_f32 v23, v23, v148
    v_add_f32 v9, v9, v149
    v_add_f32 v23, v23, v150
    v_add_f32 v9, v9, v151
    v_cvt_pk_bf16_f32 v144, v144, v145
    v_mfma_f32_32x32x16_bf16 v[80:95], v[236:239], v[136:139], v[80:95]
    ds_read_b64_tr_b16 v[236:237], v21 offset:8192
    ds_read_b64_tr_b16 v[238:239], v21 offset:10240
    v_cvt_pk_bf16_f32 v145, v146, v147
    v_cvt_pk_bf16_f32 v146, v148, v149
    v_cvt_pk_bf16_f32 v147, v150, v151
    v_fma_f32 v152, v152, s34, -v24
    v_fma_f32 v153, v153, s34, -v24
    s_waitcnt lgkmcnt(8)
    v_mfma_f32_32x32x16_bf16 v[96:111], v[216:219], v[136:139], v[96:111]
    ds_read_b64_tr_b16 v[216:217], v18 offset:12288
    ds_read_b64_tr_b16 v[218:219], v18 offset:14336
    v_fma_f32 v154, v154, s34, -v24
    v_fma_f32 v155, v155, s34, -v24
    v_fma_f32 v156, v156, s34, -v24
    v_fma_f32 v157, v157, s34, -v24
    v_fma_f32 v158, v158, s34, -v24
    v_mfma_f32_32x32x16_bf16 v[112:127], v[220:223], v[136:139], v[112:127]
    ds_read_b64_tr_b16 v[220:221], v19 offset:12288
    ds_read_b64_tr_b16 v[222:223], v19 offset:14336
    v_fma_f32 v159, v159, s34, -v24
    v_exp_f32 v152, v152
    v_exp_f32 v153, v153
    v_exp_f32 v154, v154
    v_exp_f32 v155, v155
    s_waitcnt lgkmcnt(8)
    v_mfma_f32_32x32x16_bf16 v[64:79], v[224:227], v[144:147], v[64:79]
    ds_read_b64_tr_b16 v[224:225], v20 offset:12288
    ds_read_b64_tr_b16 v[226:227], v20 offset:14336
    v_exp_f32 v156, v156
    v_exp_f32 v157, v157
    v_exp_f32 v158, v158
    v_exp_f32 v159, v159
    v_add_f32 v23, v23, v152
    v_mfma_f32_32x32x16_bf16 v[80:95], v[228:231], v[144:147], v[80:95]
    ds_read_b64_tr_b16 v[228:229], v21 offset:12288
    ds_read_b64_tr_b16 v[230:231], v21 offset:14336
    v_add_f32 v9, v9, v153
    v_add_f32 v23, v23, v154
    v_add_f32 v9, v9, v155
    v_add_f32 v23, v23, v156
    v_add_f32 v9, v9, v157
    s_waitcnt lgkmcnt(8)
    v_mfma_f32_32x32x16_bf16 v[96:111], v[232:235], v[144:147], v[96:111]
    v_add_f32 v23, v23, v158
    v_add_f32 v9, v9, v159
    v_cvt_pk_bf16_f32 v152, v152, v153
    v_cvt_pk_bf16_f32 v153, v154, v155
    v_cvt_pk_bf16_f32 v154, v156, v157
    v_cvt_pk_bf16_f32 v155, v158, v159
    v_mfma_f32_32x32x16_bf16 v[112:127], v[236:239], v[144:147], v[112:127]
    s_waitcnt lgkmcnt(4)
    v_mfma_f32_32x32x16_bf16 v[64:79], v[216:219], v[152:155], v[64:79]
    v_mfma_f32_32x32x16_bf16 v[80:95], v[220:223], v[152:155], v[80:95]
    s_waitcnt lgkmcnt(0)
    v_mfma_f32_32x32x16_bf16 v[96:111], v[224:227], v[152:155], v[96:111]
    v_mfma_f32_32x32x16_bf16 v[112:127], v[228:231], v[152:155], v[112:127]
    s_barrier
    v_add_u32 v18, 81920, v29
    v_xor_b32 v19, 64, v18
    v_xor_b32 v20, 128, v18
    v_xor_b32 v21, 192, v18
    ds_read_b64_tr_b16 v[216:217], v18 offset:0
    ds_read_b64_tr_b16 v[218:219], v18 offset:2048
    ds_read_b64_tr_b16 v[220:221], v19 offset:0
    ds_read_b64_tr_b16 v[222:223], v19 offset:2048
    ds_read_b64_tr_b16 v[224:225], v20 offset:0
    ds_read_b64_tr_b16 v[226:227], v20 offset:2048
    ds_read_b64_tr_b16 v[228:229], v21 offset:0
    ds_read_b64_tr_b16 v[230:231], v21 offset:2048
    ds_read_b64_tr_b16 v[232:233], v18 offset:4096
    ds_read_b64_tr_b16 v[234:235], v18 offset:6144
    ds_read_b64_tr_b16 v[236:237], v19 offset:4096
    ds_read_b64_tr_b16 v[238:239], v19 offset:6144
    v_max3_f32 v26, v160, v161, v162
    v_max3_f32 v27, v176, v177, v178
    v_max3_f32 v26, v26, v163, v164
    v_max3_f32 v27, v27, v179, v180
    v_max3_f32 v26, v26, v165, v166
    v_max3_f32 v27, v27, v181, v182
    v_max3_f32 v26, v26, v167, v168
    v_max3_f32 v27, v27, v183, v184
    v_max3_f32 v26, v26, v169, v170
    v_max3_f32 v27, v27, v185, v186
    v_max3_f32 v26, v26, v171, v172
    v_max3_f32 v27, v27, v187, v188
    v_max3_f32 v26, v26, v173, v174
    v_max3_f32 v27, v27, v189, v190
    v_max_f32 v26, v26, v175
    v_max_f32 v27, v27, v191
    v_max_f32 v26, v26, v27
    v_mov_b32 v27, v26
    s_nop 1
    v_permlane32_swap_b32 v26, v27
    v_max_f32 v26, v26, v27
    v_sub_f32 v27, v26, v22
    v_cmp_lt_f32 vcc, s61, v27
    s_nop 4
    s_cbranch_vccz attn_kernel_lz25
    v_max_f32 v26, v26, v22
    v_sub_f32 v27, v22, v26
    v_mul_f32 v27, s34, v27
    v_exp_f32 v25, v27
    v_mov_b32 v22, v26
    v_mul_f32 v24, s34, v26
    v_mul_f32 v23, v23, v25
    v_mul_f32 v9, v9, v25
    s_nop 11
    v_mul_f32 v64, v64, v25
    v_mul_f32 v65, v65, v25
    v_mul_f32 v66, v66, v25
    v_mul_f32 v67, v67, v25
    v_mul_f32 v68, v68, v25
    v_mul_f32 v69, v69, v25
    v_mul_f32 v70, v70, v25
    v_mul_f32 v71, v71, v25
    v_mul_f32 v72, v72, v25
    v_mul_f32 v73, v73, v25
    v_mul_f32 v74, v74, v25
    v_mul_f32 v75, v75, v25
    v_mul_f32 v76, v76, v25
    v_mul_f32 v77, v77, v25
    v_mul_f32 v78, v78, v25
    v_mul_f32 v79, v79, v25
    v_mul_f32 v80, v80, v25
    v_mul_f32 v81, v81, v25
    v_mul_f32 v82, v82, v25
    v_mul_f32 v83, v83, v25
    v_mul_f32 v84, v84, v25
    v_mul_f32 v85, v85, v25
    v_mul_f32 v86, v86, v25
    v_mul_f32 v87, v87, v25
    v_mul_f32 v88, v88, v25
    v_mul_f32 v89, v89, v25
    v_mul_f32 v90, v90, v25
    v_mul_f32 v91, v91, v25
    v_mul_f32 v92, v92, v25
    v_mul_f32 v93, v93, v25
    v_mul_f32 v94, v94, v25
    v_mul_f32 v95, v95, v25
    v_mul_f32 v96, v96, v25
    v_mul_f32 v97, v97, v25
    v_mul_f32 v98, v98, v25
    v_mul_f32 v99, v99, v25
    v_mul_f32 v100, v100, v25
    v_mul_f32 v101, v101, v25
    v_mul_f32 v102, v102, v25
    v_mul_f32 v103, v103, v25
    v_mul_f32 v104, v104, v25
    v_mul_f32 v105, v105, v25
    v_mul_f32 v106, v106, v25
    v_mul_f32 v107, v107, v25
    v_mul_f32 v108, v108, v25
    v_mul_f32 v109, v109, v25
    v_mul_f32 v110, v110, v25
    v_mul_f32 v111, v111, v25
    v_mul_f32 v112, v112, v25
    v_mul_f32 v113, v113, v25
    v_mul_f32 v114, v114, v25
    v_mul_f32 v115, v115, v25
    v_mul_f32 v116, v116, v25
    v_mul_f32 v117, v117, v25
    v_mul_f32 v118, v118, v25
    v_mul_f32 v119, v119, v25
    v_mul_f32 v120, v120, v25
    v_mul_f32 v121, v121, v25
    v_mul_f32 v122, v122, v25
    v_mul_f32 v123, v123, v25
    v_mul_f32 v124, v124, v25
    v_mul_f32 v125, v125, v25
    v_mul_f32 v126, v126, v25
    v_mul_f32 v127, v127, v25
    s_nop 1
attn_kernel_lz25:
    v_fma_f32 v160, v160, s34, -v24
    v_fma_f32 v161, v161, s34, -v24
    v_fma_f32 v162, v162, s34, -v24
    v_fma_f32 v163, v163, s34, -v24
    v_fma_f32 v164, v164, s34, -v24
    v_fma_f32 v165, v165, s34, -v24
    v_fma_f32 v166, v166, s34, -v24
    v_fma_f32 v167, v167, s34, -v24
    v_exp_f32 v160, v160
    v_exp_f32 v161, v161
    v_exp_f32 v162, v162
    v_exp_f32 v163, v163
    v_exp_f32 v164, v164
    v_exp_f32 v165, v165
    v_exp_f32 v166, v166
    v_exp_f32 v167, v167
    v_add_f32 v23, v23, v160
    v_add_f32 v9, v9, v161
    v_add_f32 v23, v23, v162
    v_add_f32 v9, v9, v163
    v_add_f32 v23, v23, v164
    v_add_f32 v9, v9, v165
    v_add_f32 v23, v23, v166
    v_add_f32 v9, v9, v167
    v_cvt_pk_bf16_f32 v160, v160, v161
    v_cvt_pk_bf16_f32 v161, v162, v163
    v_cvt_pk_bf16_f32 v162, v164, v165
    v_cvt_pk_bf16_f32 v163, v166, v167
    v_fma_f32 v168, v168, s34, -v24
    v_fma_f32 v169, v169, s34, -v24
    v_fma_f32 v170, v170, s34, -v24
    v_fma_f32 v171, v171, s34, -v24
    v_fma_f32 v172, v172, s34, -v24
    v_fma_f32 v173, v173, s34, -v24
    v_fma_f32 v174, v174, s34, -v24
    v_fma_f32 v175, v175, s34, -v24
    v_exp_f32 v168, v168
    v_exp_f32 v169, v169
    v_exp_f32 v170, v170
    v_exp_f32 v171, v171
    v_exp_f32 v172, v172
    v_exp_f32 v173, v173
    v_exp_f32 v174, v174
    v_exp_f32 v175, v175
    v_add_f32 v23, v23, v168
    v_add_f32 v9, v9, v169
    v_add_f32 v23, v23, v170
    v_add_f32 v9, v9, v171
    v_add_f32 v23, v23, v172
    v_add_f32 v9, v9, v173
    v_add_f32 v23, v23, v174
    v_add_f32 v9, v9, v175
    v_cvt_pk_bf16_f32 v168, v168, v169
    v_cvt_pk_bf16_f32 v169, v170, v171
    v_cvt_pk_bf16_f32 v170, v172, v173
    v_cvt_pk_bf16_f32 v171, v174, v175
    s_waitcnt lgkmcnt(8)
    v_mfma_f32_32x32x16_bf16 v[64:79], v[216:219], v[160:163], v[64:79]
    ds_read_b64_tr_b16 v[216:217], v20 offset:4096
    ds_read_b64_tr_b16 v[218:219], v20 offset:6144
    v_fma_f32 v176, v176, s34, -v24
    v_fma_f32 v177, v177, s34, -v24
    v_fma_f32 v178, v178, s34, -v24
    v_fma_f32 v179, v179, s34, -v24
    v_fma_f32 v180, v180, s34, -v24
    v_mfma_f32_32x32x16_bf16 v[80:95], v[220:223], v[160:163], v[80:95]
    ds_read_b64_tr_b16 v[220:221], v21 offset:4096
    ds_read_b64_tr_b16 v[222:223], v21 offset:6144
    v_fma_f32 v181, v181, s34, -v24
    v_fma_f32 v182, v182, s34, -v24
    v_fma_f32 v183, v183, s34, -v24
    v_exp_f32 v176, v176
    v_exp_f32 v177, v177
    s_waitcnt lgkmcnt(8)
    v_mfma_f32_32x32x16_bf16 v[96:111], v[224:227], v[160:163], v[96:111]
    ds_read_b64_tr_b16 v[224:225], v18 offset:8192
    ds_read_b64_tr_b16 v[226:227], v18 offset:10240
    v_exp_f32 v178, v178
    v_exp_f32 v179, v179
    v_exp_f32 v180, v180
    v_exp_f32 v181, v181
    v_exp_f32 v182, v182
    v_mfma_f32_32x32x16_bf16 v[112:127], v[228:231], v[160:163], v[112:127]
    ds_read_b64_tr_b16 v[228:229], v19 offset:8192
    ds_read_b64_tr_b16 v[230:231], v19 offset:10240
    v_exp_f32 v183, v183
    v_add_f32 v23, v23, v176
    v_add_f32 v9, v9, v177
    v_add_f32 v23, v23, v178
    v_add_f32 v9, v9, v179
    s_waitcnt lgkmcnt(8)
    v_mfma_f32_32x32x16_bf16 v[64:79], v[232:235], v[168:171], v[64:79]
    ds_read_b64_tr_b16 v[232:233], v20 offset:8192
    ds_read_b64_tr_b16 v[234:235], v20 offset:10240
    v_add_f32 v23, v23, v180
    v_add_f32 v9, v9, v181
    v_add_f32 v23, v23, v182
    v_add_f32 v9, v9, v183
    v_cvt_pk_bf16_f32 v176, v176, v177
    v_mfma_f32_32x32x16_bf16 v[80:95], v[236:239], v[168:171], v[80:95]
    ds_read_b64_tr_b16 v[236:237], v21 offset:8192
    ds_read_b64_tr_b16 v[238:239], v21 offset:10240
    v_cvt_pk_bf16_f32 v177, v178, v179
    v_cvt_pk_bf16_f32 v178, v180, v181
    v_cvt_pk_bf16_f32 v179, v182, v183
    v_fma_f32 v184, v184, s34, -v24
    v_fma_f32 v185, v185, s34, -v24
    s_waitcnt lgkmcnt(8)
    v_mfma_f32_32x32x16_bf16 v[96:111], v[216:219], v[168:171], v[96:111]
    ds_read_b64_tr_b16 v[216:217], v18 offset:12288
    ds_read_b64_tr_b16 v[218:219], v18 offset:14336
    v_fma_f32 v186, v186, s34, -v24
    v_fma_f32 v187, v187, s34, -v24
    v_fma_f32 v188, v188, s34, -v24
    v_fma_f32 v189, v189, s34, -v24
    v_fma_f32 v190, v190, s34, -v24
    v_mfma_f32_32x32x16_bf16 v[112:127], v[220:223], v[168:171], v[112:127]
    ds_read_b64_tr_b16 v[220:221], v19 offset:12288
    ds_read_b64_tr_b16 v[222:223], v19 offset:14336
    v_fma_f32 v191, v191, s34, -v24
    v_exp_f32 v184, v184
    v_exp_f32 v185, v185
    v_exp_f32 v186, v186
    v_exp_f32 v187, v187
    s_waitcnt lgkmcnt(8)
    v_mfma_f32_32x32x16_bf16 v[64:79], v[224:227], v[176:179], v[64:79]
    ds_read_b64_tr_b16 v[224:225], v20 offset:12288
    ds_read_b64_tr_b16 v[226:227], v20 offset:14336
    v_exp_f32 v188, v188
    v_exp_f32 v189, v189
    v_exp_f32 v190, v190
    v_exp_f32 v191, v191
    v_add_f32 v23, v23, v184
    v_mfma_f32_32x32x16_bf16 v[80:95], v[228:231], v[176:179], v[80:95]
    ds_read_b64_tr_b16 v[228:229], v21 offset:12288
    ds_read_b64_tr_b16 v[230:231], v21 offset:14336
    v_add_f32 v9, v9, v185
    v_add_f32 v23, v23, v186
    v_add_f32 v9, v9, v187
    v_add_f32 v23, v23, v188
    v_add_f32 v9, v9, v189
    s_waitcnt lgkmcnt(8)
    v_mfma_f32_32x32x16_bf16 v[96:111], v[232:235], v[176:179], v[96:111]
    v_add_f32 v23, v23, v190
    v_add_f32 v9, v9, v191
    v_cvt_pk_bf16_f32 v184, v184, v185
    v_cvt_pk_bf16_f32 v185, v186, v187
    v_cvt_pk_bf16_f32 v186, v188, v189
    v_cvt_pk_bf16_f32 v187, v190, v191
    v_mfma_f32_32x32x16_bf16 v[112:127], v[236:239], v[176:179], v[112:127]
    s_waitcnt lgkmcnt(4)
    v_mfma_f32_32x32x16_bf16 v[64:79], v[216:219], v[184:187], v[64:79]
    v_mfma_f32_32x32x16_bf16 v[80:95], v[220:223], v[184:187], v[80:95]
    s_waitcnt lgkmcnt(0)
    v_mfma_f32_32x32x16_bf16 v[96:111], v[224:227], v[184:187], v[96:111]
    v_mfma_f32_32x32x16_bf16 v[112:127], v[228:231], v[184:187], v[112:127]
    s_barrier
    v_add_f32 v23, v23, v9
    v_mov_b32 v26, v23
    s_nop 1
    v_permlane32_swap_b32 v26, v23
    v_add_f32 v23, v23, v26
    v_rcp_f32 v25, v23
    v_bfe_u32 v2, v1, 4, 1
    v_lshlrev_b32 v2, 13, v2
    v_lshrrev_b32 v3, 5, v1
    v_lshlrev_b32 v3, 4, v3
    v_and_b32 v4, 15, v1
    v_add3_u32 v2, v2, v3, v4
    v_lshlrev_b32 v2, 4, v2
    s_mul_i32 s33, s31, 9
    s_lshl_b32 s36, s37, 1
    s_add_u32 s33, s33, s36
    s_lshl_b32 s33, s33, 7
    s_lshl_b32 s36, s30, 2
    s_add_u32 s33, s33, s36
    s_lshl_b32 s33, s33, 10
    v_mul_f32 v64, v64, v25
    v_mul_f32 v65, v65, v25
    v_mul_f32 v66, v66, v25
    v_mul_f32 v67, v67, v25
    v_mul_f32 v68, v68, v25
    v_mul_f32 v69, v69, v25
    v_mul_f32 v70, v70, v25
    v_mul_f32 v71, v71, v25
    v_cvt_pk_bf16_f32 v128, v64, v65
    v_cvt_pk_bf16_f32 v129, v66, v67
    v_cvt_pk_bf16_f32 v130, v68, v69
    v_cvt_pk_bf16_f32 v131, v70, v71
    buffer_store_dwordx4 v[128:131], v2, s[24:27], s33 offen offset:0
    v_mul_f32 v72, v72, v25
    v_mul_f32 v73, v73, v25
    v_mul_f32 v74, v74, v25
    v_mul_f32 v75, v75, v25
    v_mul_f32 v76, v76, v25
    v_mul_f32 v77, v77, v25
    v_mul_f32 v78, v78, v25
    v_mul_f32 v79, v79, v25
    v_cvt_pk_bf16_f32 v132, v72, v73
    v_cvt_pk_bf16_f32 v133, v74, v75
    v_cvt_pk_bf16_f32 v134, v76, v77
    v_cvt_pk_bf16_f32 v135, v78, v79
    buffer_store_dwordx4 v[132:135], v2, s[24:27], s33 offen offset:512
    v_mul_f32 v80, v80, v25
    v_mul_f32 v81, v81, v25
    v_mul_f32 v82, v82, v25
    v_mul_f32 v83, v83, v25
    v_mul_f32 v84, v84, v25
    v_mul_f32 v85, v85, v25
    v_mul_f32 v86, v86, v25
    v_mul_f32 v87, v87, v25
    v_cvt_pk_bf16_f32 v136, v80, v81
    v_cvt_pk_bf16_f32 v137, v82, v83
    v_cvt_pk_bf16_f32 v138, v84, v85
    v_cvt_pk_bf16_f32 v139, v86, v87
    buffer_store_dwordx4 v[136:139], v2, s[24:27], s33 offen offset:1024
    v_mul_f32 v88, v88, v25
    v_mul_f32 v89, v89, v25
    v_mul_f32 v90, v90, v25
    v_mul_f32 v91, v91, v25
    v_mul_f32 v92, v92, v25
    v_mul_f32 v93, v93, v25
    v_mul_f32 v94, v94, v25
    v_mul_f32 v95, v95, v25
    v_cvt_pk_bf16_f32 v140, v88, v89
    v_cvt_pk_bf16_f32 v141, v90, v91
    v_cvt_pk_bf16_f32 v142, v92, v93
    v_cvt_pk_bf16_f32 v143, v94, v95
    buffer_store_dwordx4 v[140:143], v2, s[24:27], s33 offen offset:1536
    v_mul_f32 v96, v96, v25
    v_mul_f32 v97, v97, v25
    v_mul_f32 v98, v98, v25
    v_mul_f32 v99, v99, v25
    v_mul_f32 v100, v100, v25
    v_mul_f32 v101, v101, v25
    v_mul_f32 v102, v102, v25
    v_mul_f32 v103, v103, v25
    v_cvt_pk_bf16_f32 v144, v96, v97
    v_cvt_pk_bf16_f32 v145, v98, v99
    v_cvt_pk_bf16_f32 v146, v100, v101
    v_cvt_pk_bf16_f32 v147, v102, v103
    buffer_store_dwordx4 v[144:147], v2, s[24:27], s33 offen offset:2048
    v_mul_f32 v104, v104, v25
    v_mul_f32 v105, v105, v25
    v_mul_f32 v106, v106, v25
    v_mul_f32 v107, v107, v25
    v_mul_f32 v108, v108, v25
    v_mul_f32 v109, v109, v25
    v_mul_f32 v110, v110, v25
    v_mul_f32 v111, v111, v25
    v_cvt_pk_bf16_f32 v148, v104, v105
    v_cvt_pk_bf16_f32 v149, v106, v107
    v_cvt_pk_bf16_f32 v150, v108, v109
    v_cvt_pk_bf16_f32 v151, v110, v111
    buffer_store_dwordx4 v[148:151], v2, s[24:27], s33 offen offset:2560
    v_mul_f32 v112, v112, v25
    v_mul_f32 v113, v113, v25
    v_mul_f32 v114, v114, v25
    v_mul_f32 v115, v115, v25
    v_mul_f32 v116, v116, v25
    v_mul_f32 v117, v117, v25
    v_mul_f32 v118, v118, v25
    v_mul_f32 v119, v119, v25
    v_cvt_pk_bf16_f32 v152, v112, v113
    v_cvt_pk_bf16_f32 v153, v114, v115
    v_cvt_pk_bf16_f32 v154, v116, v117
    v_cvt_pk_bf16_f32 v155, v118, v119
    buffer_store_dwordx4 v[152:155], v2, s[24:27], s33 offen offset:3072
    v_mul_f32 v120, v120, v25
    v_mul_f32 v121, v121, v25
    v_mul_f32 v122, v122, v25
    v_mul_f32 v123, v123, v25
    v_mul_f32 v124, v124, v25
    v_mul_f32 v125, v125, v25
    v_mul_f32 v126, v126, v25
    v_mul_f32 v127, v127, v25
    v_cvt_pk_bf16_f32 v156, v120, v121
    v_cvt_pk_bf16_f32 v157, v122, v123
    v_cvt_pk_bf16_f32 v158, v124, v125
    v_cvt_pk_bf16_f32 v159, v126, v127
    buffer_store_dwordx4 v[156:159], v2, s[24:27], s33 offen offset:3584
    s_endpgm
attn_kernel_AUX18:
    s_setprio 2
    v_add_u32 v5, 114688, v8
    ds_read_b128 v[32:35], v5 offset:0
    ds_read_b128 v[36:39], v5 offset:1024
    ds_read_b128 v[40:43], v5 offset:2048
    ds_read_b128 v[44:47], v5 offset:3072
    v_lshrrev_b32 v2, 4, v1
    v_and_b32 v3, 15, v1
    v_bfe_u32 v4, v1, 2, 2
    v_and_b32 v5, 3, v1
    s_lshl_b32 s33, s37, 4
    v_add_u32 v6, s33, v3
    v_lshlrev_b32 v6, 8, v6
    v_xor_b32 v7, v2, v3
    v_lshlrev_b32 v7, 4, v7
    v_add_u32 v28, v6, v7
    v_lshlrev_b32 v6, 2, v2
    v_add3_u32 v6, v6, v4, s33
    v_lshlrev_b32 v6, 8, v6
    v_lshlrev_b32 v7, 2, v4
    v_xor_b32 v7, v7, v5
    v_and_b32 v9, 1, v2
    v_lshlrev_b32 v9, 1, v9
    v_xor_b32 v7, v7, v9
    v_lshlrev_b32 v7, 4, v7
    v_add_u32 v29, v6, v7
    s_waitcnt lgkmcnt(0)
    s_waitcnt vmcnt(12)
    s_barrier
    s_mov_b32 s36, 16384
    s_add_u32 m0, s44, 65536
    s_nop 0
    buffer_load_dwordx4 v31, s[16:19], s36 offen offset:0 nt lds
    s_mov_b32 s36, 20480
    s_add_u32 m0, s44, 69632
    s_nop 0
    buffer_load_dwordx4 v31, s[16:19], s36 offen offset:0 nt lds
    s_mov_b32 s36, 24576
    s_add_u32 m0, s44, 73728
    s_nop 0
    buffer_load_dwordx4 v31, s[16:19], s36 offen offset:0 nt lds
    s_mov_b32 s36, 28672
    s_add_u32 m0, s44, 77824
    s_nop 0
    buffer_load_dwordx4 v31, s[16:19], s36 offen offset:0 nt lds
    s_mov_b32 s36, 49152
    s_add_u32 m0, s44, 81920
    s_nop 0
    buffer_load_dwordx4 v30, s[12:15], s36 offen offset:0 nt lds
    s_mov_b32 s36, 53248
    s_add_u32 m0, s44, 86016
    s_nop 0
    buffer_load_dwordx4 v30, s[12:15], s36 offen offset:0 nt lds
    s_mov_b32 s36, 57344
    s_add_u32 m0, s44, 90112
    s_nop 0
    buffer_load_dwordx4 v30, s[12:15], s36 offen offset:0 nt lds
    s_mov_b32 s36, 61440
    s_add_u32 m0, s44, 94208
    s_nop 0
    buffer_load_dwordx4 v30, s[12:15], s36 offen offset:0 nt lds
    v_add_u32 v10, 0, v28
    v_xor_b32 v11, 64, v10
    v_xor_b32 v12, 128, v10
    v_xor_b32 v13, 192, v10
    ds_read_b128 v[104:107], v10 offset:0
    ds_read_b128 v[108:111], v11 offset:0
    ds_read_b128 v[112:115], v12 offset:0
    ds_read_b128 v[116:119], v13 offset:0
    s_waitcnt lgkmcnt(3)
    v_mfma_f32_16x16x32_bf16 v[96:99], v[104:107], v[32:35], 0
    s_waitcnt lgkmcnt(2)
    v_mfma_f32_16x16x32_bf16 v[96:99], v[108:111], v[36:39], v[96:99]
    s_waitcnt lgkmcnt(1)
    v_mfma_f32_16x16x32_bf16 v[96:99], v[112:115], v[40:43], v[96:99]
    s_waitcnt lgkmcnt(0)
    v_mfma_f32_16x16x32_bf16 v[96:99], v[116:119], v[44:47], v[96:99]
    s_nop 7
    v_max3_f32 v26, v96, v97, v98
    v_max_f32 v26, v26, v99
    v_mov_b32 v27, v26
    s_nop 1
    v_permlane16_swap_b32 v26, v27
    v_max_f32 v26, v26, v27
    v_mov_b32 v27, v26
    s_nop 1
    v_permlane32_swap_b32 v26, v27
    v_max_f32 v22, v26, v27
    v_mul_f32 v24, s34, v22
    v_fma_f32 v96, v96, s34, -v24
    v_fma_f32 v97, v97, s34, -v24
    v_fma_f32 v98, v98, s34, -v24
    v_fma_f32 v99, v99, s34, -v24
    v_exp_f32 v96, v96
    v_exp_f32 v97, v97
    v_exp_f32 v98, v98
    v_exp_f32 v99, v99
    v_mov_b32 v23, v96
    v_add_f32 v23, v23, v97
    v_add_f32 v23, v23, v98
    v_add_f32 v23, v23, v99
    v_cvt_pk_bf16_f32 v100, v96, v97
    v_cvt_pk_bf16_f32 v101, v98, v99
    s_mov_b32 s36, 32768
    s_add_u32 m0, s44, 98304
    s_nop 0
    buffer_load_dwordx4 v31, s[16:19], s36 offen offset:0 nt lds
    s_mov_b32 s36, 36864
    s_add_u32 m0, s44, 102400
    s_nop 0
    buffer_load_dwordx4 v31, s[16:19], s36 offen offset:0 nt lds
    s_mov_b32 s36, 40960
    s_add_u32 m0, s44, 106496
    s_nop 0
    buffer_load_dwordx4 v31, s[16:19], s36 offen offset:0 nt lds
    s_mov_b32 s36, 45056
    s_add_u32 m0, s44, 110592
    s_nop 0
    buffer_load_dwordx4 v31, s[16:19], s36 offen offset:0 nt lds
    s_waitcnt vmcnt(20)
    s_waitcnt vmcnt(16)
    s_barrier
    s_mov_b32 s36, 65536
    s_add_u32 m0, s44, 114688
    s_nop 0
    buffer_load_dwordx4 v30, s[12:15], s36 offen offset:0 nt lds
    s_mov_b32 s36, 69632
    s_add_u32 m0, s44, 118784
    s_nop 0
    buffer_load_dwordx4 v30, s[12:15], s36 offen offset:0 nt lds
    s_mov_b32 s36, 73728
    s_add_u32 m0, s44, 122880
    s_nop 0
    buffer_load_dwordx4 v30, s[12:15], s36 offen offset:0 nt lds
    s_mov_b32 s36, 77824
    s_add_u32 m0, s44, 126976
    s_nop 0
    buffer_load_dwordx4 v30, s[12:15], s36 offen offset:0 nt lds
    v_add_u32 v14, 32768, v29
    v_xor_b32 v15, 64, v14
    v_xor_b32 v16, 128, v14
    v_xor_b32 v17, 192, v14
    ds_read_b64_tr_b16 v[120:121], v14 offset:0
    ds_read_b64_tr_b16 v[122:123], v14 offset:8
    ds_read_b64_tr_b16 v[124:125], v15 offset:0
    ds_read_b64_tr_b16 v[126:127], v15 offset:8
    ds_read_b64_tr_b16 v[128:129], v16 offset:0
    ds_read_b64_tr_b16 v[130:131], v16 offset:8
    ds_read_b64_tr_b16 v[132:133], v17 offset:0
    ds_read_b64_tr_b16 v[134:135], v17 offset:8
    s_waitcnt lgkmcnt(7)
    v_mfma_f32_16x16x16_bf16 v[64:67], v[120:121], v[100:101], 0
    s_waitcnt lgkmcnt(6)
    v_mfma_f32_16x16x16_bf16 v[68:71], v[122:123], v[100:101], 0
    s_waitcnt lgkmcnt(5)
    v_mfma_f32_16x16x16_bf16 v[72:75], v[124:125], v[100:101], 0
    s_waitcnt lgkmcnt(4)
    v_mfma_f32_16x16x16_bf16 v[76:79], v[126:127], v[100:101], 0
    s_waitcnt lgkmcnt(3)
    v_mfma_f32_16x16x16_bf16 v[80:83], v[128:129], v[100:101], 0
    s_waitcnt lgkmcnt(2)
    v_mfma_f32_16x16x16_bf16 v[84:87], v[130:131], v[100:101], 0
    s_waitcnt lgkmcnt(1)
    v_mfma_f32_16x16x16_bf16 v[88:91], v[132:133], v[100:101], 0
    s_waitcnt lgkmcnt(0)
    v_mfma_f32_16x16x16_bf16 v[92:95], v[134:135], v[100:101], 0
    v_add_u32 v10, 16384, v28
    v_xor_b32 v11, 64, v10
    v_xor_b32 v12, 128, v10
    v_xor_b32 v13, 192, v10
    ds_read_b128 v[104:107], v10 offset:0
    ds_read_b128 v[108:111], v11 offset:0
    ds_read_b128 v[112:115], v12 offset:0
    ds_read_b128 v[116:119], v13 offset:0
    s_waitcnt lgkmcnt(3)
    v_mfma_f32_16x16x32_bf16 v[96:99], v[104:107], v[32:35], 0
    s_waitcnt lgkmcnt(2)
    v_mfma_f32_16x16x32_bf16 v[96:99], v[108:111], v[36:39], v[96:99]
    s_waitcnt lgkmcnt(1)
    v_mfma_f32_16x16x32_bf16 v[96:99], v[112:115], v[40:43], v[96:99]
    s_waitcnt lgkmcnt(0)
    v_mfma_f32_16x16x32_bf16 v[96:99], v[116:119], v[44:47], v[96:99]
    s_nop 7
    v_max3_f32 v26, v96, v97, v98
    v_max_f32 v26, v26, v99
    v_mov_b32 v27, v26
    s_nop 1
    v_permlane16_swap_b32 v26, v27
    v_max_f32 v26, v26, v27
    v_mov_b32 v27, v26
    s_nop 1
    v_permlane32_swap_b32 v26, v27
    v_max_f32 v26, v26, v27
    v_sub_f32 v27, v26, v22
    v_cmp_lt_f32 vcc, s61, v27
    s_nop 4
    s_cbranch_vccz attn_kernel_lz26
    v_max_f32 v26, v26, v22
    v_sub_f32 v27, v22, v26
    v_mul_f32 v27, s34, v27
    v_exp_f32 v25, v27
    v_mov_b32 v22, v26
    v_mul_f32 v24, s34, v26
    v_mul_f32 v23, v23, v25
    s_nop 11
    v_mul_f32 v64, v64, v25
    v_mul_f32 v65, v65, v25
    v_mul_f32 v66, v66, v25
    v_mul_f32 v67, v67, v25
    v_mul_f32 v68, v68, v25
    v_mul_f32 v69, v69, v25
    v_mul_f32 v70, v70, v25
    v_mul_f32 v71, v71, v25
    v_mul_f32 v72, v72, v25
    v_mul_f32 v73, v73, v25
    v_mul_f32 v74, v74, v25
    v_mul_f32 v75, v75, v25
    v_mul_f32 v76, v76, v25
    v_mul_f32 v77, v77, v25
    v_mul_f32 v78, v78, v25
    v_mul_f32 v79, v79, v25
    v_mul_f32 v80, v80, v25
    v_mul_f32 v81, v81, v25
    v_mul_f32 v82, v82, v25
    v_mul_f32 v83, v83, v25
    v_mul_f32 v84, v84, v25
    v_mul_f32 v85, v85, v25
    v_mul_f32 v86, v86, v25
    v_mul_f32 v87, v87, v25
    v_mul_f32 v88, v88, v25
    v_mul_f32 v89, v89, v25
    v_mul_f32 v90, v90, v25
    v_mul_f32 v91, v91, v25
    v_mul_f32 v92, v92, v25
    v_mul_f32 v93, v93, v25
    v_mul_f32 v94, v94, v25
    v_mul_f32 v95, v95, v25
    s_nop 1
attn_kernel_lz26:
    v_fma_f32 v96, v96, s34, -v24
    v_fma_f32 v97, v97, s34, -v24
    v_fma_f32 v98, v98, s34, -v24
    v_fma_f32 v99, v99, s34, -v24
    v_exp_f32 v96, v96
    v_exp_f32 v97, v97
    v_exp_f32 v98, v98
    v_exp_f32 v99, v99
    v_add_f32 v23, v23, v96
    v_add_f32 v23, v23, v97
    v_add_f32 v23, v23, v98
    v_add_f32 v23, v23, v99
    v_cvt_pk_bf16_f32 v100, v96, v97
    v_cvt_pk_bf16_f32 v101, v98, v99
    s_mov_b32 s36, 49152
    s_add_u32 m0, s44, 131072
    s_nop 0
    buffer_load_dwordx4 v31, s[16:19], s36 offen offset:0 nt lds
    s_mov_b32 s36, 53248
    s_add_u32 m0, s44, 135168
    s_nop 0
    buffer_load_dwordx4 v31, s[16:19], s36 offen offset:0 nt lds
    s_mov_b32 s36, 57344
    s_add_u32 m0, s44, 139264
    s_nop 0
    buffer_load_dwordx4 v31, s[16:19], s36 offen offset:0 nt lds
    s_mov_b32 s36, 61440
    s_add_u32 m0, s44, 143360
    s_nop 0
    buffer_load_dwordx4 v31, s[16:19], s36 offen offset:0 nt lds
    s_waitcnt vmcnt(20)
    s_waitcnt vmcnt(16)
    s_barrier
    s_mov_b32 s36, 81920
    s_add_u32 m0, s44, 147456
    s_nop 0
    buffer_load_dwordx4 v30, s[12:15], s36 offen offset:0 nt lds
    s_mov_b32 s36, 86016
    s_add_u32 m0, s44, 151552
    s_nop 0
    buffer_load_dwordx4 v30, s[12:15], s36 offen offset:0 nt lds
    s_mov_b32 s36, 90112
    s_add_u32 m0, s44, 155648
    s_nop 0
    buffer_load_dwordx4 v30, s[12:15], s36 offen offset:0 nt lds
    s_mov_b32 s36, 94208
    s_add_u32 m0, s44, 159744
    s_nop 0
    buffer_load_dwordx4 v30, s[12:15], s36 offen offset:0 nt lds
    v_add_u32 v14, 65536, v29
    v_xor_b32 v15, 64, v14
    v_xor_b32 v16, 128, v14
    v_xor_b32 v17, 192, v14
    ds_read_b64_tr_b16 v[120:121], v14 offset:0
    ds_read_b64_tr_b16 v[122:123], v14 offset:8
    ds_read_b64_tr_b16 v[124:125], v15 offset:0
    ds_read_b64_tr_b16 v[126:127], v15 offset:8
    ds_read_b64_tr_b16 v[128:129], v16 offset:0
    ds_read_b64_tr_b16 v[130:131], v16 offset:8
    ds_read_b64_tr_b16 v[132:133], v17 offset:0
    ds_read_b64_tr_b16 v[134:135], v17 offset:8
    s_waitcnt lgkmcnt(7)
    v_mfma_f32_16x16x16_bf16 v[64:67], v[120:121], v[100:101], v[64:67]
    s_waitcnt lgkmcnt(6)
    v_mfma_f32_16x16x16_bf16 v[68:71], v[122:123], v[100:101], v[68:71]
    s_waitcnt lgkmcnt(5)
    v_mfma_f32_16x16x16_bf16 v[72:75], v[124:125], v[100:101], v[72:75]
    s_waitcnt lgkmcnt(4)
    v_mfma_f32_16x16x16_bf16 v[76:79], v[126:127], v[100:101], v[76:79]
    s_waitcnt lgkmcnt(3)
    v_mfma_f32_16x16x16_bf16 v[80:83], v[128:129], v[100:101], v[80:83]
    s_waitcnt lgkmcnt(2)
    v_mfma_f32_16x16x16_bf16 v[84:87], v[130:131], v[100:101], v[84:87]
    s_waitcnt lgkmcnt(1)
    v_mfma_f32_16x16x16_bf16 v[88:91], v[132:133], v[100:101], v[88:91]
    s_waitcnt lgkmcnt(0)
    v_mfma_f32_16x16x16_bf16 v[92:95], v[134:135], v[100:101], v[92:95]
    v_add_u32 v10, 49152, v28
    v_xor_b32 v11, 64, v10
    v_xor_b32 v12, 128, v10
    v_xor_b32 v13, 192, v10
    ds_read_b128 v[104:107], v10 offset:0
    ds_read_b128 v[108:111], v11 offset:0
    ds_read_b128 v[112:115], v12 offset:0
    ds_read_b128 v[116:119], v13 offset:0
    s_waitcnt lgkmcnt(3)
    v_mfma_f32_16x16x32_bf16 v[96:99], v[104:107], v[32:35], 0
    s_waitcnt lgkmcnt(2)
    v_mfma_f32_16x16x32_bf16 v[96:99], v[108:111], v[36:39], v[96:99]
    s_waitcnt lgkmcnt(1)
    v_mfma_f32_16x16x32_bf16 v[96:99], v[112:115], v[40:43], v[96:99]
    s_waitcnt lgkmcnt(0)
    v_mfma_f32_16x16x32_bf16 v[96:99], v[116:119], v[44:47], v[96:99]
    s_nop 7
    v_max3_f32 v26, v96, v97, v98
    v_max_f32 v26, v26, v99
    v_mov_b32 v27, v26
    s_nop 1
    v_permlane16_swap_b32 v26, v27
    v_max_f32 v26, v26, v27
    v_mov_b32 v27, v26
    s_nop 1
    v_permlane32_swap_b32 v26, v27
    v_max_f32 v26, v26, v27
    v_sub_f32 v27, v26, v22
    v_cmp_lt_f32 vcc, s61, v27
    s_nop 4
    s_cbranch_vccz attn_kernel_lz27
    v_max_f32 v26, v26, v22
    v_sub_f32 v27, v22, v26
    v_mul_f32 v27, s34, v27
    v_exp_f32 v25, v27
    v_mov_b32 v22, v26
    v_mul_f32 v24, s34, v26
    v_mul_f32 v23, v23, v25
    s_nop 11
    v_mul_f32 v64, v64, v25
    v_mul_f32 v65, v65, v25
    v_mul_f32 v66, v66, v25
    v_mul_f32 v67, v67, v25
    v_mul_f32 v68, v68, v25
    v_mul_f32 v69, v69, v25
    v_mul_f32 v70, v70, v25
    v_mul_f32 v71, v71, v25
    v_mul_f32 v72, v72, v25
    v_mul_f32 v73, v73, v25
    v_mul_f32 v74, v74, v25
    v_mul_f32 v75, v75, v25
    v_mul_f32 v76, v76, v25
    v_mul_f32 v77, v77, v25
    v_mul_f32 v78, v78, v25
    v_mul_f32 v79, v79, v25
    v_mul_f32 v80, v80, v25
    v_mul_f32 v81, v81, v25
    v_mul_f32 v82, v82, v25
    v_mul_f32 v83, v83, v25
    v_mul_f32 v84, v84, v25
    v_mul_f32 v85, v85, v25
    v_mul_f32 v86, v86, v25
    v_mul_f32 v87, v87, v25
    v_mul_f32 v88, v88, v25
    v_mul_f32 v89, v89, v25
    v_mul_f32 v90, v90, v25
    v_mul_f32 v91, v91, v25
    v_mul_f32 v92, v92, v25
    v_mul_f32 v93, v93, v25
    v_mul_f32 v94, v94, v25
    v_mul_f32 v95, v95, v25
    s_nop 1
attn_kernel_lz27:
    v_fma_f32 v96, v96, s34, -v24
    v_fma_f32 v97, v97, s34, -v24
    v_fma_f32 v98, v98, s34, -v24
    v_fma_f32 v99, v99, s34, -v24
    v_exp_f32 v96, v96
    v_exp_f32 v97, v97
    v_exp_f32 v98, v98
    v_exp_f32 v99, v99
    v_add_f32 v23, v23, v96
    v_add_f32 v23, v23, v97
    v_add_f32 v23, v23, v98
    v_add_f32 v23, v23, v99
    v_cvt_pk_bf16_f32 v100, v96, v97
    v_cvt_pk_bf16_f32 v101, v98, v99
    s_mov_b32 s36, 65536
    s_add_u32 m0, s44, 0
    s_nop 0
    buffer_load_dwordx4 v31, s[16:19], s36 offen offset:0 nt lds
    s_mov_b32 s36, 69632
    s_add_u32 m0, s44, 4096
    s_nop 0
    buffer_load_dwordx4 v31, s[16:19], s36 offen offset:0 nt lds
    s_mov_b32 s36, 73728
    s_add_u32 m0, s44, 8192
    s_nop 0
    buffer_load_dwordx4 v31, s[16:19], s36 offen offset:0 nt lds
    s_mov_b32 s36, 77824
    s_add_u32 m0, s44, 12288
    s_nop 0
    buffer_load_dwordx4 v31, s[16:19], s36 offen offset:0 nt lds
    s_waitcnt vmcnt(20)
    s_waitcnt vmcnt(16)
    s_barrier
    s_mov_b32 s36, 98304
    s_add_u32 m0, s44, 16384
    s_nop 0
    buffer_load_dwordx4 v30, s[12:15], s36 offen offset:0 nt lds
    s_mov_b32 s36, 102400
    s_add_u32 m0, s44, 20480
    s_nop 0
    buffer_load_dwordx4 v30, s[12:15], s36 offen offset:0 nt lds
    s_mov_b32 s36, 106496
    s_add_u32 m0, s44, 24576
    s_nop 0
    buffer_load_dwordx4 v30, s[12:15], s36 offen offset:0 nt lds
    s_mov_b32 s36, 110592
    s_add_u32 m0, s44, 28672
    s_nop 0
    buffer_load_dwordx4 v30, s[12:15], s36 offen offset:0 nt lds
    v_add_u32 v14, 98304, v29
    v_xor_b32 v15, 64, v14
    v_xor_b32 v16, 128, v14
    v_xor_b32 v17, 192, v14
    ds_read_b64_tr_b16 v[120:121], v14 offset:0
    ds_read_b64_tr_b16 v[122:123], v14 offset:8
    ds_read_b64_tr_b16 v[124:125], v15 offset:0
    ds_read_b64_tr_b16 v[126:127], v15 offset:8
    ds_read_b64_tr_b16 v[128:129], v16 offset:0
    ds_read_b64_tr_b16 v[130:131], v16 offset:8
    ds_read_b64_tr_b16 v[132:133], v17 offset:0
    ds_read_b64_tr_b16 v[134:135], v17 offset:8
    s_waitcnt lgkmcnt(7)
    v_mfma_f32_16x16x16_bf16 v[64:67], v[120:121], v[100:101], v[64:67]
    s_waitcnt lgkmcnt(6)
    v_mfma_f32_16x16x16_bf16 v[68:71], v[122:123], v[100:101], v[68:71]
    s_waitcnt lgkmcnt(5)
    v_mfma_f32_16x16x16_bf16 v[72:75], v[124:125], v[100:101], v[72:75]
    s_waitcnt lgkmcnt(4)
    v_mfma_f32_16x16x16_bf16 v[76:79], v[126:127], v[100:101], v[76:79]
    s_waitcnt lgkmcnt(3)
    v_mfma_f32_16x16x16_bf16 v[80:83], v[128:129], v[100:101], v[80:83]
    s_waitcnt lgkmcnt(2)
    v_mfma_f32_16x16x16_bf16 v[84:87], v[130:131], v[100:101], v[84:87]
    s_waitcnt lgkmcnt(1)
    v_mfma_f32_16x16x16_bf16 v[88:91], v[132:133], v[100:101], v[88:91]
    s_waitcnt lgkmcnt(0)
    v_mfma_f32_16x16x16_bf16 v[92:95], v[134:135], v[100:101], v[92:95]
    v_add_u32 v10, 81920, v28
    v_xor_b32 v11, 64, v10
    v_xor_b32 v12, 128, v10
    v_xor_b32 v13, 192, v10
    ds_read_b128 v[104:107], v10 offset:0
    ds_read_b128 v[108:111], v11 offset:0
    ds_read_b128 v[112:115], v12 offset:0
    ds_read_b128 v[116:119], v13 offset:0
    s_waitcnt lgkmcnt(3)
    v_mfma_f32_16x16x32_bf16 v[96:99], v[104:107], v[32:35], 0
    s_waitcnt lgkmcnt(2)
    v_mfma_f32_16x16x32_bf16 v[96:99], v[108:111], v[36:39], v[96:99]
    s_waitcnt lgkmcnt(1)
    v_mfma_f32_16x16x32_bf16 v[96:99], v[112:115], v[40:43], v[96:99]
    s_waitcnt lgkmcnt(0)
    v_mfma_f32_16x16x32_bf16 v[96:99], v[116:119], v[44:47], v[96:99]
    s_nop 7
    v_max3_f32 v26, v96, v97, v98
    v_max_f32 v26, v26, v99
    v_mov_b32 v27, v26
    s_nop 1
    v_permlane16_swap_b32 v26, v27
    v_max_f32 v26, v26, v27
    v_mov_b32 v27, v26
    s_nop 1
    v_permlane32_swap_b32 v26, v27
    v_max_f32 v26, v26, v27
    v_sub_f32 v27, v26, v22
    v_cmp_lt_f32 vcc, s61, v27
    s_nop 4
    s_cbranch_vccz attn_kernel_lz28
    v_max_f32 v26, v26, v22
    v_sub_f32 v27, v22, v26
    v_mul_f32 v27, s34, v27
    v_exp_f32 v25, v27
    v_mov_b32 v22, v26
    v_mul_f32 v24, s34, v26
    v_mul_f32 v23, v23, v25
    s_nop 11
    v_mul_f32 v64, v64, v25
    v_mul_f32 v65, v65, v25
    v_mul_f32 v66, v66, v25
    v_mul_f32 v67, v67, v25
    v_mul_f32 v68, v68, v25
    v_mul_f32 v69, v69, v25
    v_mul_f32 v70, v70, v25
    v_mul_f32 v71, v71, v25
    v_mul_f32 v72, v72, v25
    v_mul_f32 v73, v73, v25
    v_mul_f32 v74, v74, v25
    v_mul_f32 v75, v75, v25
    v_mul_f32 v76, v76, v25
    v_mul_f32 v77, v77, v25
    v_mul_f32 v78, v78, v25
    v_mul_f32 v79, v79, v25
    v_mul_f32 v80, v80, v25
    v_mul_f32 v81, v81, v25
    v_mul_f32 v82, v82, v25
    v_mul_f32 v83, v83, v25
    v_mul_f32 v84, v84, v25
    v_mul_f32 v85, v85, v25
    v_mul_f32 v86, v86, v25
    v_mul_f32 v87, v87, v25
    v_mul_f32 v88, v88, v25
    v_mul_f32 v89, v89, v25
    v_mul_f32 v90, v90, v25
    v_mul_f32 v91, v91, v25
    v_mul_f32 v92, v92, v25
    v_mul_f32 v93, v93, v25
    v_mul_f32 v94, v94, v25
    v_mul_f32 v95, v95, v25
    s_nop 1
attn_kernel_lz28:
    v_fma_f32 v96, v96, s34, -v24
    v_fma_f32 v97, v97, s34, -v24
    v_fma_f32 v98, v98, s34, -v24
    v_fma_f32 v99, v99, s34, -v24
    v_exp_f32 v96, v96
    v_exp_f32 v97, v97
    v_exp_f32 v98, v98
    v_exp_f32 v99, v99
    v_add_f32 v23, v23, v96
    v_add_f32 v23, v23, v97
    v_add_f32 v23, v23, v98
    v_add_f32 v23, v23, v99
    v_cvt_pk_bf16_f32 v100, v96, v97
    v_cvt_pk_bf16_f32 v101, v98, v99
    s_mov_b32 s36, 81920
    s_add_u32 m0, s44, 32768
    s_nop 0
    buffer_load_dwordx4 v31, s[16:19], s36 offen offset:0 nt lds
    s_mov_b32 s36, 86016
    s_add_u32 m0, s44, 36864
    s_nop 0
    buffer_load_dwordx4 v31, s[16:19], s36 offen offset:0 nt lds
    s_mov_b32 s36, 90112
    s_add_u32 m0, s44, 40960
    s_nop 0
    buffer_load_dwordx4 v31, s[16:19], s36 offen offset:0 nt lds
    s_mov_b32 s36, 94208
    s_add_u32 m0, s44, 45056
    s_nop 0
    buffer_load_dwordx4 v31, s[16:19], s36 offen offset:0 nt lds
    s_waitcnt vmcnt(20)
    s_waitcnt vmcnt(16)
    s_barrier
    s_mov_b32 s36, 114688
    s_add_u32 m0, s44, 49152
    s_nop 0
    buffer_load_dwordx4 v30, s[12:15], s36 offen offset:0 nt lds
    s_mov_b32 s36, 118784
    s_add_u32 m0, s44, 53248
    s_nop 0
    buffer_load_dwordx4 v30, s[12:15], s36 offen offset:0 nt lds
    s_mov_b32 s36, 122880
    s_add_u32 m0, s44, 57344
    s_nop 0
    buffer_load_dwordx4 v30, s[12:15], s36 offen offset:0 nt lds
    s_mov_b32 s36, 126976
    s_add_u32 m0, s44, 61440
    s_nop 0
    buffer_load_dwordx4 v30, s[12:15], s36 offen offset:0 nt lds
    v_add_u32 v14, 131072, v29
    v_xor_b32 v15, 64, v14
    v_xor_b32 v16, 128, v14
    v_xor_b32 v17, 192, v14
    ds_read_b64_tr_b16 v[120:121], v14 offset:0
    ds_read_b64_tr_b16 v[122:123], v14 offset:8
    ds_read_b64_tr_b16 v[124:125], v15 offset:0
    ds_read_b64_tr_b16 v[126:127], v15 offset:8
    ds_read_b64_tr_b16 v[128:129], v16 offset:0
    ds_read_b64_tr_b16 v[130:131], v16 offset:8
    ds_read_b64_tr_b16 v[132:133], v17 offset:0
    ds_read_b64_tr_b16 v[134:135], v17 offset:8
    s_waitcnt lgkmcnt(7)
    v_mfma_f32_16x16x16_bf16 v[64:67], v[120:121], v[100:101], v[64:67]
    s_waitcnt lgkmcnt(6)
    v_mfma_f32_16x16x16_bf16 v[68:71], v[122:123], v[100:101], v[68:71]
    s_waitcnt lgkmcnt(5)
    v_mfma_f32_16x16x16_bf16 v[72:75], v[124:125], v[100:101], v[72:75]
    s_waitcnt lgkmcnt(4)
    v_mfma_f32_16x16x16_bf16 v[76:79], v[126:127], v[100:101], v[76:79]
    s_waitcnt lgkmcnt(3)
    v_mfma_f32_16x16x16_bf16 v[80:83], v[128:129], v[100:101], v[80:83]
    s_waitcnt lgkmcnt(2)
    v_mfma_f32_16x16x16_bf16 v[84:87], v[130:131], v[100:101], v[84:87]
    s_waitcnt lgkmcnt(1)
    v_mfma_f32_16x16x16_bf16 v[88:91], v[132:133], v[100:101], v[88:91]
    s_waitcnt lgkmcnt(0)
    v_mfma_f32_16x16x16_bf16 v[92:95], v[134:135], v[100:101], v[92:95]
    v_add_u32 v10, 114688, v28
    v_xor_b32 v11, 64, v10
    v_xor_b32 v12, 128, v10
    v_xor_b32 v13, 192, v10
    ds_read_b128 v[104:107], v10 offset:0
    ds_read_b128 v[108:111], v11 offset:0
    ds_read_b128 v[112:115], v12 offset:0
    ds_read_b128 v[116:119], v13 offset:0
    s_waitcnt lgkmcnt(3)
    v_mfma_f32_16x16x32_bf16 v[96:99], v[104:107], v[32:35], 0
    s_waitcnt lgkmcnt(2)
    v_mfma_f32_16x16x32_bf16 v[96:99], v[108:111], v[36:39], v[96:99]
    s_waitcnt lgkmcnt(1)
    v_mfma_f32_16x16x32_bf16 v[96:99], v[112:115], v[40:43], v[96:99]
    s_waitcnt lgkmcnt(0)
    v_mfma_f32_16x16x32_bf16 v[96:99], v[116:119], v[44:47], v[96:99]
    s_nop 7
    v_max3_f32 v26, v96, v97, v98
    v_max_f32 v26, v26, v99
    v_mov_b32 v27, v26
    s_nop 1
    v_permlane16_swap_b32 v26, v27
    v_max_f32 v26, v26, v27
    v_mov_b32 v27, v26
    s_nop 1
    v_permlane32_swap_b32 v26, v27
    v_max_f32 v26, v26, v27
    v_sub_f32 v27, v26, v22
    v_cmp_lt_f32 vcc, s61, v27
    s_nop 4
    s_cbranch_vccz attn_kernel_lz29
    v_max_f32 v26, v26, v22
    v_sub_f32 v27, v22, v26
    v_mul_f32 v27, s34, v27
    v_exp_f32 v25, v27
    v_mov_b32 v22, v26
    v_mul_f32 v24, s34, v26
    v_mul_f32 v23, v23, v25
    s_nop 11
    v_mul_f32 v64, v64, v25
    v_mul_f32 v65, v65, v25
    v_mul_f32 v66, v66, v25
    v_mul_f32 v67, v67, v25
    v_mul_f32 v68, v68, v25
    v_mul_f32 v69, v69, v25
    v_mul_f32 v70, v70, v25
    v_mul_f32 v71, v71, v25
    v_mul_f32 v72, v72, v25
    v_mul_f32 v73, v73, v25
    v_mul_f32 v74, v74, v25
    v_mul_f32 v75, v75, v25
    v_mul_f32 v76, v76, v25
    v_mul_f32 v77, v77, v25
    v_mul_f32 v78, v78, v25
    v_mul_f32 v79, v79, v25
    v_mul_f32 v80, v80, v25
    v_mul_f32 v81, v81, v25
    v_mul_f32 v82, v82, v25
    v_mul_f32 v83, v83, v25
    v_mul_f32 v84, v84, v25
    v_mul_f32 v85, v85, v25
    v_mul_f32 v86, v86, v25
    v_mul_f32 v87, v87, v25
    v_mul_f32 v88, v88, v25
    v_mul_f32 v89, v89, v25
    v_mul_f32 v90, v90, v25
    v_mul_f32 v91, v91, v25
    v_mul_f32 v92, v92, v25
    v_mul_f32 v93, v93, v25
    v_mul_f32 v94, v94, v25
    v_mul_f32 v95, v95, v25
    s_nop 1
attn_kernel_lz29:
    v_fma_f32 v96, v96, s34, -v24
    v_fma_f32 v97, v97, s34, -v24
    v_fma_f32 v98, v98, s34, -v24
    v_fma_f32 v99, v99, s34, -v24
    v_exp_f32 v96, v96
    v_exp_f32 v97, v97
    v_exp_f32 v98, v98
    v_exp_f32 v99, v99
    v_add_f32 v23, v23, v96
    v_add_f32 v23, v23, v97
    v_add_f32 v23, v23, v98
    v_add_f32 v23, v23, v99
    v_cvt_pk_bf16_f32 v100, v96, v97
    v_cvt_pk_bf16_f32 v101, v98, v99
    s_mov_b32 s36, 98304
    s_add_u32 m0, s44, 65536
    s_nop 0
    buffer_load_dwordx4 v31, s[16:19], s36 offen offset:0 nt lds
    s_mov_b32 s36, 102400
    s_add_u32 m0, s44, 69632
    s_nop 0
    buffer_load_dwordx4 v31, s[16:19], s36 offen offset:0 nt lds
    s_mov_b32 s36, 106496
    s_add_u32 m0, s44, 73728
    s_nop 0
    buffer_load_dwordx4 v31, s[16:19], s36 offen offset:0 nt lds
    s_mov_b32 s36, 110592
    s_add_u32 m0, s44, 77824
    s_nop 0
    buffer_load_dwordx4 v31, s[16:19], s36 offen offset:0 nt lds
    s_waitcnt vmcnt(20)
    s_waitcnt vmcnt(16)
    s_barrier
    s_mov_b32 s36, 114688
    s_add_u32 m0, s44, 81920
    s_nop 0
    buffer_load_dwordx4 v31, s[16:19], s36 offen offset:0 nt lds
    s_mov_b32 s36, 118784
    s_add_u32 m0, s44, 86016
    s_nop 0
    buffer_load_dwordx4 v31, s[16:19], s36 offen offset:0 nt lds
    s_mov_b32 s36, 122880
    s_add_u32 m0, s44, 90112
    s_nop 0
    buffer_load_dwordx4 v31, s[16:19], s36 offen offset:0 nt lds
    s_mov_b32 s36, 126976
    s_add_u32 m0, s44, 94208
    s_nop 0
    buffer_load_dwordx4 v31, s[16:19], s36 offen offset:0 nt lds
    v_add_u32 v14, 0, v29
    v_xor_b32 v15, 64, v14
    v_xor_b32 v16, 128, v14
    v_xor_b32 v17, 192, v14
    ds_read_b64_tr_b16 v[120:121], v14 offset:0
    ds_read_b64_tr_b16 v[122:123], v14 offset:8
    ds_read_b64_tr_b16 v[124:125], v15 offset:0
    ds_read_b64_tr_b16 v[126:127], v15 offset:8
    ds_read_b64_tr_b16 v[128:129], v16 offset:0
    ds_read_b64_tr_b16 v[130:131], v16 offset:8
    ds_read_b64_tr_b16 v[132:133], v17 offset:0
    ds_read_b64_tr_b16 v[134:135], v17 offset:8
    s_waitcnt lgkmcnt(7)
    v_mfma_f32_16x16x16_bf16 v[64:67], v[120:121], v[100:101], v[64:67]
    s_waitcnt lgkmcnt(6)
    v_mfma_f32_16x16x16_bf16 v[68:71], v[122:123], v[100:101], v[68:71]
    s_waitcnt lgkmcnt(5)
    v_mfma_f32_16x16x16_bf16 v[72:75], v[124:125], v[100:101], v[72:75]
    s_waitcnt lgkmcnt(4)
    v_mfma_f32_16x16x16_bf16 v[76:79], v[126:127], v[100:101], v[76:79]
    s_waitcnt lgkmcnt(3)
    v_mfma_f32_16x16x16_bf16 v[80:83], v[128:129], v[100:101], v[80:83]
    s_waitcnt lgkmcnt(2)
    v_mfma_f32_16x16x16_bf16 v[84:87], v[130:131], v[100:101], v[84:87]
    s_waitcnt lgkmcnt(1)
    v_mfma_f32_16x16x16_bf16 v[88:91], v[132:133], v[100:101], v[88:91]
    s_waitcnt lgkmcnt(0)
    v_mfma_f32_16x16x16_bf16 v[92:95], v[134:135], v[100:101], v[92:95]
    v_add_u32 v10, 147456, v28
    v_xor_b32 v11, 64, v10
    v_xor_b32 v12, 128, v10
    v_xor_b32 v13, 192, v10
    ds_read_b128 v[104:107], v10 offset:0
    ds_read_b128 v[108:111], v11 offset:0
    ds_read_b128 v[112:115], v12 offset:0
    ds_read_b128 v[116:119], v13 offset:0
    s_waitcnt lgkmcnt(3)
    v_mfma_f32_16x16x32_bf16 v[96:99], v[104:107], v[32:35], 0
    s_waitcnt lgkmcnt(2)
    v_mfma_f32_16x16x32_bf16 v[96:99], v[108:111], v[36:39], v[96:99]
    s_waitcnt lgkmcnt(1)
    v_mfma_f32_16x16x32_bf16 v[96:99], v[112:115], v[40:43], v[96:99]
    s_waitcnt lgkmcnt(0)
    v_mfma_f32_16x16x32_bf16 v[96:99], v[116:119], v[44:47], v[96:99]
    s_nop 7
    v_max3_f32 v26, v96, v97, v98
    v_max_f32 v26, v26, v99
    v_mov_b32 v27, v26
    s_nop 1
    v_permlane16_swap_b32 v26, v27
    v_max_f32 v26, v26, v27
    v_mov_b32 v27, v26
    s_nop 1
    v_permlane32_swap_b32 v26, v27
    v_max_f32 v26, v26, v27
    v_sub_f32 v27, v26, v22
    v_cmp_lt_f32 vcc, s61, v27
    s_nop 4
    s_cbranch_vccz attn_kernel_lz30
    v_max_f32 v26, v26, v22
    v_sub_f32 v27, v22, v26
    v_mul_f32 v27, s34, v27
    v_exp_f32 v25, v27
    v_mov_b32 v22, v26
    v_mul_f32 v24, s34, v26
    v_mul_f32 v23, v23, v25
    s_nop 11
    v_mul_f32 v64, v64, v25
    v_mul_f32 v65, v65, v25
    v_mul_f32 v66, v66, v25
    v_mul_f32 v67, v67, v25
    v_mul_f32 v68, v68, v25
    v_mul_f32 v69, v69, v25
    v_mul_f32 v70, v70, v25
    v_mul_f32 v71, v71, v25
    v_mul_f32 v72, v72, v25
    v_mul_f32 v73, v73, v25
    v_mul_f32 v74, v74, v25
    v_mul_f32 v75, v75, v25
    v_mul_f32 v76, v76, v25
    v_mul_f32 v77, v77, v25
    v_mul_f32 v78, v78, v25
    v_mul_f32 v79, v79, v25
    v_mul_f32 v80, v80, v25
    v_mul_f32 v81, v81, v25
    v_mul_f32 v82, v82, v25
    v_mul_f32 v83, v83, v25
    v_mul_f32 v84, v84, v25
    v_mul_f32 v85, v85, v25
    v_mul_f32 v86, v86, v25
    v_mul_f32 v87, v87, v25
    v_mul_f32 v88, v88, v25
    v_mul_f32 v89, v89, v25
    v_mul_f32 v90, v90, v25
    v_mul_f32 v91, v91, v25
    v_mul_f32 v92, v92, v25
    v_mul_f32 v93, v93, v25
    v_mul_f32 v94, v94, v25
    v_mul_f32 v95, v95, v25
    s_nop 1
attn_kernel_lz30:
    v_fma_f32 v96, v96, s34, -v24
    v_fma_f32 v97, v97, s34, -v24
    v_fma_f32 v98, v98, s34, -v24
    v_fma_f32 v99, v99, s34, -v24
    v_exp_f32 v96, v96
    v_exp_f32 v97, v97
    v_exp_f32 v98, v98
    v_exp_f32 v99, v99
    v_add_f32 v23, v23, v96
    v_add_f32 v23, v23, v97
    v_add_f32 v23, v23, v98
    v_add_f32 v23, v23, v99
    v_cvt_pk_bf16_f32 v100, v96, v97
    v_cvt_pk_bf16_f32 v101, v98, v99
    s_lshr_b32 s33, s2, 1
    s_mul_i32 s33, s33, 36864
    s_and_b32 s36, s2, 1
    s_mul_i32 s36, s36, 576
    s_add_u32 s33, s33, s36
    s_sub_u32 s58, 4718592, s33
    s_add_u32 s56, s56, s33
    s_addc_u32 s57, s57, 0
    s_and_b32 s57, s57, 0xffff
    s_mov_b32 s59, 0x00020000
    s_mul_i32 s33, s37, 5
    s_add_u32 s33, s33, 0
    s_min_u32 s33, s33, 17
    s_lshl_b32 s36, s33, 6
    v_add_u32 v2, s36, v1
    v_mul_u32_u24 v3, 0x1c72, v2
    v_lshrrev_b32 v3, 18, v3
    v_mul_u32_u24 v4, 36, v3
    v_sub_u32 v4, v2, v4
    v_lshlrev_b32 v4, 4, v4
    v_mul_u32_u24 v3, 1152, v3
    v_add_u32 v3, v3, v4
    s_lshl_b32 s33, s33, 10
    s_add_u32 m0, s33, 98304
    s_nop 0
    buffer_load_dwordx4 v3, s[56:59], 0 offen offset:0 lds
    s_mul_i32 s33, s37, 5
    s_add_u32 s33, s33, 1
    s_min_u32 s33, s33, 17
    s_lshl_b32 s36, s33, 6
    v_add_u32 v2, s36, v1
    v_mul_u32_u24 v3, 0x1c72, v2
    v_lshrrev_b32 v3, 18, v3
    v_mul_u32_u24 v4, 36, v3
    v_sub_u32 v4, v2, v4
    v_lshlrev_b32 v4, 4, v4
    v_mul_u32_u24 v3, 1152, v3
    v_add_u32 v3, v3, v4
    s_lshl_b32 s33, s33, 10
    s_add_u32 m0, s33, 98304
    s_nop 0
    buffer_load_dwordx4 v3, s[56:59], 0 offen offset:0 lds
    s_mul_i32 s33, s37, 5
    s_add_u32 s33, s33, 2
    s_min_u32 s33, s33, 17
    s_lshl_b32 s36, s33, 6
    v_add_u32 v2, s36, v1
    v_mul_u32_u24 v3, 0x1c72, v2
    v_lshrrev_b32 v3, 18, v3
    v_mul_u32_u24 v4, 36, v3
    v_sub_u32 v4, v2, v4
    v_lshlrev_b32 v4, 4, v4
    v_mul_u32_u24 v3, 1152, v3
    v_add_u32 v3, v3, v4
    s_lshl_b32 s33, s33, 10
    s_add_u32 m0, s33, 98304
    s_nop 0
    buffer_load_dwordx4 v3, s[56:59], 0 offen offset:0 lds
    s_mul_i32 s33, s37, 5
    s_add_u32 s33, s33, 3
    s_min_u32 s33, s33, 17
    s_lshl_b32 s36, s33, 6
    v_add_u32 v2, s36, v1
    v_mul_u32_u24 v3, 0x1c72, v2
    v_lshrrev_b32 v3, 18, v3
    v_mul_u32_u24 v4, 36, v3
    v_sub_u32 v4, v2, v4
    v_lshlrev_b32 v4, 4, v4
    v_mul_u32_u24 v3, 1152, v3
    v_add_u32 v3, v3, v4
    s_lshl_b32 s33, s33, 10
    s_add_u32 m0, s33, 98304
    s_nop 0
    buffer_load_dwordx4 v3, s[56:59], 0 offen offset:0 lds
    s_mul_i32 s33, s37, 5
    s_add_u32 s33, s33, 4
    s_min_u32 s33, s33, 17
    s_lshl_b32 s36, s33, 6
    v_add_u32 v2, s36, v1
    v_mul_u32_u24 v3, 0x1c72, v2
    v_lshrrev_b32 v3, 18, v3
    v_mul_u32_u24 v4, 36, v3
    v_sub_u32 v4, v2, v4
    v_lshlrev_b32 v4, 4, v4
    v_mul_u32_u24 v3, 1152, v3
    v_add_u32 v3, v3, v4
    s_lshl_b32 s33, s33, 10
    s_add_u32 m0, s33, 98304
    s_nop 0
    buffer_load_dwordx4 v3, s[56:59], 0 offen offset:0 lds
    s_waitcnt vmcnt(21)
    s_waitcnt vmcnt(17)
    s_barrier
    v_add_u32 v14, 32768, v29
    v_xor_b32 v15, 64, v14
    v_xor_b32 v16, 128, v14
    v_xor_b32 v17, 192, v14
    ds_read_b64_tr_b16 v[120:121], v14 offset:0
    ds_read_b64_tr_b16 v[122:123], v14 offset:8
    ds_read_b64_tr_b16 v[124:125], v15 offset:0
    ds_read_b64_tr_b16 v[126:127], v15 offset:8
    ds_read_b64_tr_b16 v[128:129], v16 offset:0
    ds_read_b64_tr_b16 v[130:131], v16 offset:8
    ds_read_b64_tr_b16 v[132:133], v17 offset:0
    ds_read_b64_tr_b16 v[134:135], v17 offset:8
    s_waitcnt lgkmcnt(7)
    v_mfma_f32_16x16x16_bf16 v[64:67], v[120:121], v[100:101], v[64:67]
    s_waitcnt lgkmcnt(6)
    v_mfma_f32_16x16x16_bf16 v[68:71], v[122:123], v[100:101], v[68:71]
    s_waitcnt lgkmcnt(5)
    v_mfma_f32_16x16x16_bf16 v[72:75], v[124:125], v[100:101], v[72:75]
    s_waitcnt lgkmcnt(4)
    v_mfma_f32_16x16x16_bf16 v[76:79], v[126:127], v[100:101], v[76:79]
    s_waitcnt lgkmcnt(3)
    v_mfma_f32_16x16x16_bf16 v[80:83], v[128:129], v[100:101], v[80:83]
    s_waitcnt lgkmcnt(2)
    v_mfma_f32_16x16x16_bf16 v[84:87], v[130:131], v[100:101], v[84:87]
    s_waitcnt lgkmcnt(1)
    v_mfma_f32_16x16x16_bf16 v[88:91], v[132:133], v[100:101], v[88:91]
    s_waitcnt lgkmcnt(0)
    v_mfma_f32_16x16x16_bf16 v[92:95], v[134:135], v[100:101], v[92:95]
    v_add_u32 v10, 16384, v28
    v_xor_b32 v11, 64, v10
    v_xor_b32 v12, 128, v10
    v_xor_b32 v13, 192, v10
    ds_read_b128 v[104:107], v10 offset:0
    ds_read_b128 v[108:111], v11 offset:0
    ds_read_b128 v[112:115], v12 offset:0
    ds_read_b128 v[116:119], v13 offset:0
    s_waitcnt lgkmcnt(3)
    v_mfma_f32_16x16x32_bf16 v[96:99], v[104:107], v[32:35], 0
    s_waitcnt lgkmcnt(2)
    v_mfma_f32_16x16x32_bf16 v[96:99], v[108:111], v[36:39], v[96:99]
    s_waitcnt lgkmcnt(1)
    v_mfma_f32_16x16x32_bf16 v[96:99], v[112:115], v[40:43], v[96:99]
    s_waitcnt lgkmcnt(0)
    v_mfma_f32_16x16x32_bf16 v[96:99], v[116:119], v[44:47], v[96:99]
    s_nop 7
    v_max3_f32 v26, v96, v97, v98
    v_max_f32 v26, v26, v99
    v_mov_b32 v27, v26
    s_nop 1
    v_permlane16_swap_b32 v26, v27
    v_max_f32 v26, v26, v27
    v_mov_b32 v27, v26
    s_nop 1
    v_permlane32_swap_b32 v26, v27
    v_max_f32 v26, v26, v27
    v_sub_f32 v27, v26, v22
    v_cmp_lt_f32 vcc, s61, v27
    s_nop 4
    s_cbranch_vccz attn_kernel_lz31
    v_max_f32 v26, v26, v22
    v_sub_f32 v27, v22, v26
    v_mul_f32 v27, s34, v27
    v_exp_f32 v25, v27
    v_mov_b32 v22, v26
    v_mul_f32 v24, s34, v26
    v_mul_f32 v23, v23, v25
    s_nop 11
    v_mul_f32 v64, v64, v25
    v_mul_f32 v65, v65, v25
    v_mul_f32 v66, v66, v25
    v_mul_f32 v67, v67, v25
    v_mul_f32 v68, v68, v25
    v_mul_f32 v69, v69, v25
    v_mul_f32 v70, v70, v25
    v_mul_f32 v71, v71, v25
    v_mul_f32 v72, v72, v25
    v_mul_f32 v73, v73, v25
    v_mul_f32 v74, v74, v25
    v_mul_f32 v75, v75, v25
    v_mul_f32 v76, v76, v25
    v_mul_f32 v77, v77, v25
    v_mul_f32 v78, v78, v25
    v_mul_f32 v79, v79, v25
    v_mul_f32 v80, v80, v25
    v_mul_f32 v81, v81, v25
    v_mul_f32 v82, v82, v25
    v_mul_f32 v83, v83, v25
    v_mul_f32 v84, v84, v25
    v_mul_f32 v85, v85, v25
    v_mul_f32 v86, v86, v25
    v_mul_f32 v87, v87, v25
    v_mul_f32 v88, v88, v25
    v_mul_f32 v89, v89, v25
    v_mul_f32 v90, v90, v25
    v_mul_f32 v91, v91, v25
    v_mul_f32 v92, v92, v25
    v_mul_f32 v93, v93, v25
    v_mul_f32 v94, v94, v25
    v_mul_f32 v95, v95, v25
    s_nop 1
attn_kernel_lz31:
    v_fma_f32 v96, v96, s34, -v24
    v_fma_f32 v97, v97, s34, -v24
    v_fma_f32 v98, v98, s34, -v24
    v_fma_f32 v99, v99, s34, -v24
    v_exp_f32 v96, v96
    v_exp_f32 v97, v97
    v_exp_f32 v98, v98
    v_exp_f32 v99, v99
    v_add_f32 v23, v23, v96
    v_add_f32 v23, v23, v97
    v_add_f32 v23, v23, v98
    v_add_f32 v23, v23, v99
    v_cvt_pk_bf16_f32 v100, v96, v97
    v_cvt_pk_bf16_f32 v101, v98, v99
    s_waitcnt vmcnt(13)
    s_waitcnt vmcnt(9)
    s_waitcnt vmcnt(0)
    s_barrier
    v_add_u32 v14, 65536, v29
    v_xor_b32 v15, 64, v14
    v_xor_b32 v16, 128, v14
    v_xor_b32 v17, 192, v14
    ds_read_b64_tr_b16 v[120:121], v14 offset:0
    ds_read_b64_tr_b16 v[122:123], v14 offset:8
    ds_read_b64_tr_b16 v[124:125], v15 offset:0
    ds_read_b64_tr_b16 v[126:127], v15 offset:8
    ds_read_b64_tr_b16 v[128:129], v16 offset:0
    ds_read_b64_tr_b16 v[130:131], v16 offset:8
    ds_read_b64_tr_b16 v[132:133], v17 offset:0
    ds_read_b64_tr_b16 v[134:135], v17 offset:8
    s_waitcnt lgkmcnt(7)
    v_mfma_f32_16x16x16_bf16 v[64:67], v[120:121], v[100:101], v[64:67]
    s_waitcnt lgkmcnt(6)
    v_mfma_f32_16x16x16_bf16 v[68:71], v[122:123], v[100:101], v[68:71]
    s_waitcnt lgkmcnt(5)
    v_mfma_f32_16x16x16_bf16 v[72:75], v[124:125], v[100:101], v[72:75]
    s_waitcnt lgkmcnt(4)
    v_mfma_f32_16x16x16_bf16 v[76:79], v[126:127], v[100:101], v[76:79]
    s_waitcnt lgkmcnt(3)
    v_mfma_f32_16x16x16_bf16 v[80:83], v[128:129], v[100:101], v[80:83]
    s_waitcnt lgkmcnt(2)
    v_mfma_f32_16x16x16_bf16 v[84:87], v[130:131], v[100:101], v[84:87]
    s_waitcnt lgkmcnt(1)
    v_mfma_f32_16x16x16_bf16 v[88:91], v[132:133], v[100:101], v[88:91]
    s_waitcnt lgkmcnt(0)
    v_mfma_f32_16x16x16_bf16 v[92:95], v[134:135], v[100:101], v[92:95]
    v_add_u32 v10, 49152, v28
    v_xor_b32 v11, 64, v10
    v_xor_b32 v12, 128, v10
    v_xor_b32 v13, 192, v10
    ds_read_b128 v[104:107], v10 offset:0
    ds_read_b128 v[108:111], v11 offset:0
    ds_read_b128 v[112:115], v12 offset:0
    ds_read_b128 v[116:119], v13 offset:0
    s_waitcnt lgkmcnt(3)
    v_mfma_f32_16x16x32_bf16 v[96:99], v[104:107], v[32:35], 0
    s_waitcnt lgkmcnt(2)
    v_mfma_f32_16x16x32_bf16 v[96:99], v[108:111], v[36:39], v[96:99]
    s_waitcnt lgkmcnt(1)
    v_mfma_f32_16x16x32_bf16 v[96:99], v[112:115], v[40:43], v[96:99]
    s_waitcnt lgkmcnt(0)
    v_mfma_f32_16x16x32_bf16 v[96:99], v[116:119], v[44:47], v[96:99]
    s_nop 7
    v_max3_f32 v26, v96, v97, v98
    v_max_f32 v26, v26, v99
    v_mov_b32 v27, v26
    s_nop 1
    v_permlane16_swap_b32 v26, v27
    v_max_f32 v26, v26, v27
    v_mov_b32 v27, v26
    s_nop 1
    v_permlane32_swap_b32 v26, v27
    v_max_f32 v26, v26, v27
    v_sub_f32 v27, v26, v22
    v_cmp_lt_f32 vcc, s61, v27
    s_nop 4
    s_cbranch_vccz attn_kernel_lz32
    v_max_f32 v26, v26, v22
    v_sub_f32 v27, v22, v26
    v_mul_f32 v27, s34, v27
    v_exp_f32 v25, v27
    v_mov_b32 v22, v26
    v_mul_f32 v24, s34, v26
    v_mul_f32 v23, v23, v25
    s_nop 11
    v_mul_f32 v64, v64, v25
    v_mul_f32 v65, v65, v25
    v_mul_f32 v66, v66, v25
    v_mul_f32 v67, v67, v25
    v_mul_f32 v68, v68, v25
    v_mul_f32 v69, v69, v25
    v_mul_f32 v70, v70, v25
    v_mul_f32 v71, v71, v25
    v_mul_f32 v72, v72, v25
    v_mul_f32 v73, v73, v25
    v_mul_f32 v74, v74, v25
    v_mul_f32 v75, v75, v25
    v_mul_f32 v76, v76, v25
    v_mul_f32 v77, v77, v25
    v_mul_f32 v78, v78, v25
    v_mul_f32 v79, v79, v25
    v_mul_f32 v80, v80, v25
    v_mul_f32 v81, v81, v25
    v_mul_f32 v82, v82, v25
    v_mul_f32 v83, v83, v25
    v_mul_f32 v84, v84, v25
    v_mul_f32 v85, v85, v25
    v_mul_f32 v86, v86, v25
    v_mul_f32 v87, v87, v25
    v_mul_f32 v88, v88, v25
    v_mul_f32 v89, v89, v25
    v_mul_f32 v90, v90, v25
    v_mul_f32 v91, v91, v25
    v_mul_f32 v92, v92, v25
    v_mul_f32 v93, v93, v25
    v_mul_f32 v94, v94, v25
    v_mul_f32 v95, v95, v25
    s_nop 1
attn_kernel_lz32:
    v_fma_f32 v96, v96, s34, -v24
    v_fma_f32 v97, v97, s34, -v24
    v_fma_f32 v98, v98, s34, -v24
    v_fma_f32 v99, v99, s34, -v24
    v_exp_f32 v96, v96
    v_exp_f32 v97, v97
    v_exp_f32 v98, v98
    v_exp_f32 v99, v99
    v_add_f32 v23, v23, v96
    v_add_f32 v23, v23, v97
    v_add_f32 v23, v23, v98
    v_add_f32 v23, v23, v99
    v_cvt_pk_bf16_f32 v100, v96, v97
    v_cvt_pk_bf16_f32 v101, v98, v99
    v_lshrrev_b32 v2, 4, v1
    v_bfe_u32 v3, v1, 2, 2
    v_lshlrev_b32 v2, 3, v2
    v_add_u32 v2, v2, v3
    v_mul_u32_u24 v2, 576, v2
    v_and_b32 v3, 3, v1
    v_lshlrev_b32 v3, 3, v3
    v_add_u32 v2, v2, v3
    v_add_u32 v2, 98304, v2
    s_add_u32 s33, s37, 0
    s_min_u32 s33, s33, 17
    s_lshl_b32 s36, s33, 5
    v_add_u32 v3, s36, v2
    ds_read_b64_tr_b16 v[140:141], v3 offset:0
    ds_read_b64_tr_b16 v[142:143], v3 offset:2304
    s_add_u32 s33, s37, 4
    s_min_u32 s33, s33, 17
    s_lshl_b32 s36, s33, 5
    v_add_u32 v3, s36, v2
    ds_read_b64_tr_b16 v[144:145], v3 offset:0
    ds_read_b64_tr_b16 v[146:147], v3 offset:2304
    s_add_u32 s33, s37, 8
    s_min_u32 s33, s33, 17
    s_lshl_b32 s36, s33, 5
    v_add_u32 v3, s36, v2
    ds_read_b64_tr_b16 v[148:149], v3 offset:0
    ds_read_b64_tr_b16 v[150:151], v3 offset:2304
    s_add_u32 s33, s37, 12
    s_min_u32 s33, s33, 17
    s_lshl_b32 s36, s33, 5
    v_add_u32 v3, s36, v2
    ds_read_b64_tr_b16 v[152:153], v3 offset:0
    ds_read_b64_tr_b16 v[154:155], v3 offset:2304
    s_add_u32 s33, s37, 16
    s_min_u32 s33, s33, 17
    s_lshl_b32 s36, s33, 5
    v_add_u32 v3, s36, v2
    ds_read_b64_tr_b16 v[156:157], v3 offset:0
    ds_read_b64_tr_b16 v[158:159], v3 offset:2304
    s_mov_b32 s45, s28
    s_and_b32 s49, s29, 0xffff
    s_mov_b32 s48, s28
    s_mov_b32 s50, 21495808
    s_mov_b32 s51, 0x00020000
    s_add_u32 s33, s37, 0
    s_min_u32 s33, s33, 17
    s_lshr_b32 s36, s2, 1
    s_mul_i32 s36, s36, 36
    s_add_u32 s33, s33, s36
    s_and_b32 s36, s2, 1
    s_mul_i32 s36, s36, 18
    s_add_u32 s33, s33, s36
    s_lshl_b32 s33, s33, 10
    s_add_u32 s33, s33, 16777216
    s_waitcnt lgkmcnt(8)
    buffer_store_dwordx4 v[140:143], v8, s[48:51], s33 offen offset:0
    s_add_u32 s33, s37, 4
    s_min_u32 s33, s33, 17
    s_lshr_b32 s36, s2, 1
    s_mul_i32 s36, s36, 36
    s_add_u32 s33, s33, s36
    s_and_b32 s36, s2, 1
    s_mul_i32 s36, s36, 18
    s_add_u32 s33, s33, s36
    s_lshl_b32 s33, s33, 10
    s_add_u32 s33, s33, 16777216
    s_waitcnt lgkmcnt(6)
    buffer_store_dwordx4 v[144:147], v8, s[48:51], s33 offen offset:0
    s_add_u32 s33, s37, 8
    s_min_u32 s33, s33, 17
    s_lshr_b32 s36, s2, 1
    s_mul_i32 s36, s36, 36
    s_add_u32 s33, s33, s36
    s_and_b32 s36, s2, 1
    s_mul_i32 s36, s36, 18
    s_add_u32 s33, s33, s36
    s_lshl_b32 s33, s33, 10
    s_add_u32 s33, s33, 16777216
    s_waitcnt lgkmcnt(4)
    buffer_store_dwordx4 v[148:151], v8, s[48:51], s33 offen offset:0
    s_add_u32 s33, s37, 12
    s_min_u32 s33, s33, 17
    s_lshr_b32 s36, s2, 1
    s_mul_i32 s36, s36, 36
    s_add_u32 s33, s33, s36
    s_and_b32 s36, s2, 1
    s_mul_i32 s36, s36, 18
    s_add_u32 s33, s33, s36
    s_lshl_b32 s33, s33, 10
    s_add_u32 s33, s33, 16777216
    s_waitcnt lgkmcnt(2)
    buffer_store_dwordx4 v[152:155], v8, s[48:51], s33 offen offset:0
    s_add_u32 s33, s37, 16
    s_min_u32 s33, s33, 17
    s_lshr_b32 s36, s2, 1
    s_mul_i32 s36, s36, 36
    s_add_u32 s33, s33, s36
    s_and_b32 s36, s2, 1
    s_mul_i32 s36, s36, 18
    s_add_u32 s33, s33, s36
    s_lshl_b32 s33, s33, 10
    s_add_u32 s33, s33, 16777216
    s_waitcnt lgkmcnt(0)
    buffer_store_dwordx4 v[156:159], v8, s[48:51], s33 offen offset:0
    s_barrier
    v_add_u32 v14, 81920, v29
    v_xor_b32 v15, 64, v14
    v_xor_b32 v16, 128, v14
    v_xor_b32 v17, 192, v14
    ds_read_b64_tr_b16 v[120:121], v14 offset:0
    ds_read_b64_tr_b16 v[122:123], v14 offset:8
    ds_read_b64_tr_b16 v[124:125], v15 offset:0
    ds_read_b64_tr_b16 v[126:127], v15 offset:8
    ds_read_b64_tr_b16 v[128:129], v16 offset:0
    ds_read_b64_tr_b16 v[130:131], v16 offset:8
    ds_read_b64_tr_b16 v[132:133], v17 offset:0
    ds_read_b64_tr_b16 v[134:135], v17 offset:8
    s_waitcnt lgkmcnt(7)
    v_mfma_f32_16x16x16_bf16 v[64:67], v[120:121], v[100:101], v[64:67]
    s_waitcnt lgkmcnt(6)
    v_mfma_f32_16x16x16_bf16 v[68:71], v[122:123], v[100:101], v[68:71]
    s_waitcnt lgkmcnt(5)
    v_mfma_f32_16x16x16_bf16 v[72:75], v[124:125], v[100:101], v[72:75]
    s_waitcnt lgkmcnt(4)
    v_mfma_f32_16x16x16_bf16 v[76:79], v[126:127], v[100:101], v[76:79]
    s_waitcnt lgkmcnt(3)
    v_mfma_f32_16x16x16_bf16 v[80:83], v[128:129], v[100:101], v[80:83]
    s_waitcnt lgkmcnt(2)
    v_mfma_f32_16x16x16_bf16 v[84:87], v[130:131], v[100:101], v[84:87]
    s_waitcnt lgkmcnt(1)
    v_mfma_f32_16x16x16_bf16 v[88:91], v[132:133], v[100:101], v[88:91]
    s_waitcnt lgkmcnt(0)
    v_mfma_f32_16x16x16_bf16 v[92:95], v[134:135], v[100:101], v[92:95]
    v_mov_b32 v27, v23
    s_nop 1
    v_permlane16_swap_b32 v23, v27
    v_add_f32 v23, v23, v27
    v_mov_b32 v27, v23
    s_nop 1
    v_permlane32_swap_b32 v23, v27
    v_add_f32 v23, v23, v27
    s_lshl_b32 s33, s37, 13
    v_add_u32 v2, 131072, v8
    v_add_u32 v3, s33, v2
    ds_write_b128 v3, v[64:67] offset:0
    ds_write_b128 v3, v[68:71] offset:1024
    ds_write_b128 v3, v[72:75] offset:2048
    ds_write_b128 v3, v[76:79] offset:3072
    ds_write_b128 v3, v[80:83] offset:4096
    ds_write_b128 v3, v[84:87] offset:5120
    ds_write_b128 v3, v[88:91] offset:6144
    ds_write_b128 v3, v[92:95] offset:7168
    v_lshrrev_b32 v4, 1, v8
    s_lshl_b32 s33, s37, 9
    v_add_u32 v5, s33, v4
    ds_write_b64 v5, v[22:23] offset:0
    s_waitcnt lgkmcnt(0)
    s_barrier
    ds_read_b64 v[128:129], v4 offset:0
    ds_read_b64 v[130:131], v4 offset:512
    ds_read_b64 v[132:133], v4 offset:1024
    ds_read_b64 v[134:135], v4 offset:1536
    s_lshl_b32 s33, s37, 11
    v_add_u32 v3, s33, v2
    ds_read_b128 v[136:139], v3 offset:0
    ds_read_b128 v[140:143], v3 offset:1024
    ds_read_b128 v[144:147], v3 offset:8192
    ds_read_b128 v[148:151], v3 offset:9216
    ds_read_b128 v[152:155], v3 offset:16384
    ds_read_b128 v[156:159], v3 offset:17408
    ds_read_b128 v[160:163], v3 offset:24576
    ds_read_b128 v[164:167], v3 offset:25600
    s_waitcnt lgkmcnt(8)
    v_max3_f32 v22, v128, v130, v132
    v_max_f32 v22, v22, v134
    v_sub_f32 v128, v128, v22
    v_mul_f32 v128, s34, v128
    v_sub_f32 v130, v130, v22
    v_mul_f32 v130, s34, v130
    v_sub_f32 v132, v132, v22
    v_mul_f32 v132, s34, v132
    v_sub_f32 v134, v134, v22
    v_mul_f32 v134, s34, v134
    v_exp_f32 v128, v128
    v_exp_f32 v130, v130
    v_exp_f32 v132, v132
    v_exp_f32 v134, v134
    v_mul_f32 v23, v128, v129
    v_fma_f32 v23, v130, v131, v23
    v_fma_f32 v23, v132, v133, v23
    v_fma_f32 v23, v134, v135, v23
    v_rcp_f32 v25, v23
    s_nop 0
    v_mul_f32 v128, v128, v25
    v_mul_f32 v130, v130, v25
    v_mul_f32 v132, v132, v25
    v_mul_f32 v134, v134, v25
    s_waitcnt lgkmcnt(0)
    v_mul_f32 v136, v136, v128
    v_fma_f32 v136, v144, v130, v136
    v_fma_f32 v136, v152, v132, v136
    v_fma_f32 v136, v160, v134, v136
    v_mul_f32 v137, v137, v128
    v_fma_f32 v137, v145, v130, v137
    v_fma_f32 v137, v153, v132, v137
    v_fma_f32 v137, v161, v134, v137
    v_mul_f32 v138, v138, v128
    v_fma_f32 v138, v146, v130, v138
    v_fma_f32 v138, v154, v132, v138
    v_fma_f32 v138, v162, v134, v138
    v_mul_f32 v139, v139, v128
    v_fma_f32 v139, v147, v130, v139
    v_fma_f32 v139, v155, v132, v139
    v_fma_f32 v139, v163, v134, v139
    v_mul_f32 v140, v140, v128
    v_fma_f32 v140, v148, v130, v140
    v_fma_f32 v140, v156, v132, v140
    v_fma_f32 v140, v164, v134, v140
    v_mul_f32 v141, v141, v128
    v_fma_f32 v141, v149, v130, v141
    v_fma_f32 v141, v157, v132, v141
    v_fma_f32 v141, v165, v134, v141
    v_mul_f32 v142, v142, v128
    v_fma_f32 v142, v150, v130, v142
    v_fma_f32 v142, v158, v132, v142
    v_fma_f32 v142, v166, v134, v142
    v_mul_f32 v143, v143, v128
    v_fma_f32 v143, v151, v130, v143
    v_fma_f32 v143, v159, v132, v143
    v_fma_f32 v143, v167, v134, v143
    v_cvt_pk_bf16_f32 v32, v136, v137
    v_cvt_pk_bf16_f32 v33, v138, v139
    v_cvt_pk_bf16_f32 v34, v140, v141
    v_cvt_pk_bf16_f32 v35, v142, v143
    s_mul_i32 s33, s31, 9
    s_add_u32 s33, s33, 8
    s_lshl_b32 s33, s33, 7
    s_lshl_b32 s36, s30, 2
    s_add_u32 s33, s33, s36
    s_add_u32 s33, s33, s37
    s_lshl_b32 s33, s33, 10
    buffer_store_dwordx4 v[32:35], v8, s[24:27], s33 offen offset:0
attn_kernel_done:
    s_endpgm
.globl oproj_kernel
.p2align 8
.type oproj_kernel,@function
oproj_kernel:
    s_cmp_ge_u32 s2, 216
    s_cbranch_scc1 oproj_kernel_done
    s_load_dwordx2 s[6:7], s[0:1], 40
    s_load_dwordx2 s[20:21], s[0:1], 56
    s_and_b32 s22, s2, 7
    s_lshr_b32 s23, s2, 3
    s_mul_i32 s24, s23, 0x5556
    s_lshr_b32 s24, s24, 16
    s_mul_i32 s25, s24, 3
    s_sub_u32 s25, s23, s25
    v_and_b32 v1, 63, v0
    v_lshrrev_b32 v2, 6, v0
    s_nop 0
    v_readfirstlane_b32 s26, v2
    v_lshlrev_b32 v4, 4, v1
    v_add_u32 v5, 0x20000, v4
    v_add_u32 v6, 0x40000, v4
    s_mul_i32 s27, s22, 9
    s_mul_i32 s28, s25, 3
    s_add_u32 s27, s27, s28
    s_lshl_b32 s27, s27, 7
    s_lshl_b32 s28, s26, 5
    s_add_u32 s27, s27, s28
    s_lshl_b32 s27, s27, 10
    s_mul_i32 s28, s26, 1152
    s_lshl_b32 s29, s24, 2
    s_add_u32 s28, s28, s29
    s_lshl_b32 s28, s28, 10
    s_add_u32 s28, s28, 16777216
    s_waitcnt lgkmcnt(0)
    s_mov_b32 s12, s20
    s_and_b32 s13, s21, 0xffff
    s_mov_b32 s14, 21495808
    s_mov_b32 s15, 0x00020000
    s_mov_b32 s16, s6
    s_and_b32 s17, s7, 0xffff
    s_mov_b32 s18, 1327104
    s_mov_b32 s19, 0x00020000
    buffer_load_dwordx4 v[76:79], v4, s[12:15], s28 offen offset:0
    buffer_load_dwordx4 v[80:83], v4, s[12:15], s28 offen offset:1024
    buffer_load_dwordx4 v[84:87], v4, s[12:15], s28 offen offset:2048
    buffer_load_dwordx4 v[88:91], v4, s[12:15], s28 offen offset:3072
    buffer_load_dwordx4 v[64:67], v4, s[12:15], s27 offen offset:0
    buffer_load_dwordx4 v[68:71], v5, s[12:15], s27 offen offset:0
    buffer_load_dwordx4 v[72:75], v6, s[12:15], s27 offen offset:0
    s_add_u32 s28, s28, 36864
    s_add_u32 s27, s27, 1024
    buffer_load_dwordx4 v[104:107], v4, s[12:15], s28 offen offset:0
    buffer_load_dwordx4 v[108:111], v4, s[12:15], s28 offen offset:1024
    buffer_load_dwordx4 v[112:115], v4, s[12:15], s28 offen offset:2048
    buffer_load_dwordx4 v[116:119], v4, s[12:15], s28 offen offset:3072
    buffer_load_dwordx4 v[92:95], v4, s[12:15], s27 offen offset:0
    buffer_load_dwordx4 v[96:99], v5, s[12:15], s27 offen offset:0
    buffer_load_dwordx4 v[100:103], v6, s[12:15], s27 offen offset:0
    s_add_u32 s28, s28, 36864
    s_add_u32 s27, s27, 1024
    buffer_load_dwordx4 v[132:135], v4, s[12:15], s28 offen offset:0
    buffer_load_dwordx4 v[136:139], v4, s[12:15], s28 offen offset:1024
    buffer_load_dwordx4 v[140:143], v4, s[12:15], s28 offen offset:2048
    buffer_load_dwordx4 v[144:147], v4, s[12:15], s28 offen offset:3072
    buffer_load_dwordx4 v[120:123], v4, s[12:15], s27 offen offset:0
    buffer_load_dwordx4 v[124:127], v5, s[12:15], s27 offen offset:0
    buffer_load_dwordx4 v[128:131], v6, s[12:15], s27 offen offset:0
    s_add_u32 s28, s28, 36864
    s_add_u32 s27, s27, 1024
    buffer_load_dwordx4 v[160:163], v4, s[12:15], s28 offen offset:0
    buffer_load_dwordx4 v[164:167], v4, s[12:15], s28 offen offset:1024
    buffer_load_dwordx4 v[168:171], v4, s[12:15], s28 offen offset:2048
    buffer_load_dwordx4 v[172:175], v4, s[12:15], s28 offen offset:3072
    buffer_load_dwordx4 v[148:151], v4, s[12:15], s27 offen offset:0
    buffer_load_dwordx4 v[152:155], v5, s[12:15], s27 offen offset:0
    buffer_load_dwordx4 v[156:159], v6, s[12:15], s27 offen offset:0
    s_add_u32 s28, s28, 36864
    s_add_u32 s27, s27, 1024
    buffer_load_dwordx4 v[188:191], v4, s[12:15], s28 offen offset:0
    buffer_load_dwordx4 v[192:195], v4, s[12:15], s28 offen offset:1024
    buffer_load_dwordx4 v[196:199], v4, s[12:15], s28 offen offset:2048
    buffer_load_dwordx4 v[200:203], v4, s[12:15], s28 offen offset:3072
    buffer_load_dwordx4 v[176:179], v4, s[12:15], s27 offen offset:0
    buffer_load_dwordx4 v[180:183], v5, s[12:15], s27 offen offset:0
    buffer_load_dwordx4 v[184:187], v6, s[12:15], s27 offen offset:0
    s_add_u32 s28, s28, 36864
    s_add_u32 s27, s27, 1024
    s_waitcnt vmcnt(28)
    v_mfma_f32_16x16x32_bf16 v[16:19], v[76:79], v[64:67], 0
    v_mfma_f32_16x16x32_bf16 v[20:23], v[76:79], v[68:71], 0
    v_mfma_f32_16x16x32_bf16 v[24:27], v[76:79], v[72:75], 0
    v_mfma_f32_16x16x32_bf16 v[28:31], v[80:83], v[64:67], 0
    v_mfma_f32_16x16x32_bf16 v[32:35], v[80:83], v[68:71], 0
    v_mfma_f32_16x16x32_bf16 v[36:39], v[80:83], v[72:75], 0
    v_mfma_f32_16x16x32_bf16 v[40:43], v[84:87], v[64:67], 0
    v_mfma_f32_16x16x32_bf16 v[44:47], v[84:87], v[68:71], 0
    v_mfma_f32_16x16x32_bf16 v[48:51], v[84:87], v[72:75], 0
    v_mfma_f32_16x16x32_bf16 v[52:55], v[88:91], v[64:67], 0
    v_mfma_f32_16x16x32_bf16 v[56:59], v[88:91], v[68:71], 0
    v_mfma_f32_16x16x32_bf16 v[60:63], v[88:91], v[72:75], 0
    buffer_load_dwordx4 v[76:79], v4, s[12:15], s28 offen offset:0
    buffer_load_dwordx4 v[80:83], v4, s[12:15], s28 offen offset:1024
    buffer_load_dwordx4 v[84:87], v4, s[12:15], s28 offen offset:2048
    buffer_load_dwordx4 v[88:91], v4, s[12:15], s28 offen offset:3072
    buffer_load_dwordx4 v[64:67], v4, s[12:15], s27 offen offset:0
    buffer_load_dwordx4 v[68:71], v5, s[12:15], s27 offen offset:0
    buffer_load_dwordx4 v[72:75], v6, s[12:15], s27 offen offset:0
    s_add_u32 s28, s28, 36864
    s_add_u32 s27, s27, 1024
    s_waitcnt vmcnt(28)
    v_mfma_f32_16x16x32_bf16 v[16:19], v[104:107], v[92:95], v[16:19]
    v_mfma_f32_16x16x32_bf16 v[20:23], v[104:107], v[96:99], v[20:23]
    v_mfma_f32_16x16x32_bf16 v[24:27], v[104:107], v[100:103], v[24:27]
    v_mfma_f32_16x16x32_bf16 v[28:31], v[108:111], v[92:95], v[28:31]
    v_mfma_f32_16x16x32_bf16 v[32:35], v[108:111], v[96:99], v[32:35]
    v_mfma_f32_16x16x32_bf16 v[36:39], v[108:111], v[100:103], v[36:39]
    v_mfma_f32_16x16x32_bf16 v[40:43], v[112:115], v[92:95], v[40:43]
    v_mfma_f32_16x16x32_bf16 v[44:47], v[112:115], v[96:99], v[44:47]
    v_mfma_f32_16x16x32_bf16 v[48:51], v[112:115], v[100:103], v[48:51]
    v_mfma_f32_16x16x32_bf16 v[52:55], v[116:119], v[92:95], v[52:55]
    v_mfma_f32_16x16x32_bf16 v[56:59], v[116:119], v[96:99], v[56:59]
    v_mfma_f32_16x16x32_bf16 v[60:63], v[116:119], v[100:103], v[60:63]
    buffer_load_dwordx4 v[104:107], v4, s[12:15], s28 offen offset:0
    buffer_load_dwordx4 v[108:111], v4, s[12:15], s28 offen offset:1024
    buffer_load_dwordx4 v[112:115], v4, s[12:15], s28 offen offset:2048
    buffer_load_dwordx4 v[116:119], v4, s[12:15], s28 offen offset:3072
    buffer_load_dwordx4 v[92:95], v4, s[12:15], s27 offen offset:0
    buffer_load_dwordx4 v[96:99], v5, s[12:15], s27 offen offset:0
    buffer_load_dwordx4 v[100:103], v6, s[12:15], s27 offen offset:0
    s_add_u32 s28, s28, 36864
    s_add_u32 s27, s27, 1024
    s_waitcnt vmcnt(28)
    v_mfma_f32_16x16x32_bf16 v[16:19], v[132:135], v[120:123], v[16:19]
    v_mfma_f32_16x16x32_bf16 v[20:23], v[132:135], v[124:127], v[20:23]
    v_mfma_f32_16x16x32_bf16 v[24:27], v[132:135], v[128:131], v[24:27]
    v_mfma_f32_16x16x32_bf16 v[28:31], v[136:139], v[120:123], v[28:31]
    v_mfma_f32_16x16x32_bf16 v[32:35], v[136:139], v[124:127], v[32:35]
    v_mfma_f32_16x16x32_bf16 v[36:39], v[136:139], v[128:131], v[36:39]
    v_mfma_f32_16x16x32_bf16 v[40:43], v[140:143], v[120:123], v[40:43]
    v_mfma_f32_16x16x32_bf16 v[44:47], v[140:143], v[124:127], v[44:47]
    v_mfma_f32_16x16x32_bf16 v[48:51], v[140:143], v[128:131], v[48:51]
    v_mfma_f32_16x16x32_bf16 v[52:55], v[144:147], v[120:123], v[52:55]
    v_mfma_f32_16x16x32_bf16 v[56:59], v[144:147], v[124:127], v[56:59]
    v_mfma_f32_16x16x32_bf16 v[60:63], v[144:147], v[128:131], v[60:63]
    buffer_load_dwordx4 v[132:135], v4, s[12:15], s28 offen offset:0
    buffer_load_dwordx4 v[136:139], v4, s[12:15], s28 offen offset:1024
    buffer_load_dwordx4 v[140:143], v4, s[12:15], s28 offen offset:2048
    buffer_load_dwordx4 v[144:147], v4, s[12:15], s28 offen offset:3072
    buffer_load_dwordx4 v[120:123], v4, s[12:15], s27 offen offset:0
    buffer_load_dwordx4 v[124:127], v5, s[12:15], s27 offen offset:0
    buffer_load_dwordx4 v[128:131], v6, s[12:15], s27 offen offset:0
    s_add_u32 s28, s28, 36864
    s_add_u32 s27, s27, 1024
    s_waitcnt vmcnt(28)
    v_mfma_f32_16x16x32_bf16 v[16:19], v[160:163], v[148:151], v[16:19]
    v_mfma_f32_16x16x32_bf16 v[20:23], v[160:163], v[152:155], v[20:23]
    v_mfma_f32_16x16x32_bf16 v[24:27], v[160:163], v[156:159], v[24:27]
    v_mfma_f32_16x16x32_bf16 v[28:31], v[164:167], v[148:151], v[28:31]
    v_mfma_f32_16x16x32_bf16 v[32:35], v[164:167], v[152:155], v[32:35]
    v_mfma_f32_16x16x32_bf16 v[36:39], v[164:167], v[156:159], v[36:39]
    v_mfma_f32_16x16x32_bf16 v[40:43], v[168:171], v[148:151], v[40:43]
    v_mfma_f32_16x16x32_bf16 v[44:47], v[168:171], v[152:155], v[44:47]
    v_mfma_f32_16x16x32_bf16 v[48:51], v[168:171], v[156:159], v[48:51]
    v_mfma_f32_16x16x32_bf16 v[52:55], v[172:175], v[148:151], v[52:55]
    v_mfma_f32_16x16x32_bf16 v[56:59], v[172:175], v[152:155], v[56:59]
    v_mfma_f32_16x16x32_bf16 v[60:63], v[172:175], v[156:159], v[60:63]
    buffer_load_dwordx4 v[160:163], v4, s[12:15], s28 offen offset:0
    buffer_load_dwordx4 v[164:167], v4, s[12:15], s28 offen offset:1024
    buffer_load_dwordx4 v[168:171], v4, s[12:15], s28 offen offset:2048
    buffer_load_dwordx4 v[172:175], v4, s[12:15], s28 offen offset:3072
    buffer_load_dwordx4 v[148:151], v4, s[12:15], s27 offen offset:0
    buffer_load_dwordx4 v[152:155], v5, s[12:15], s27 offen offset:0
    buffer_load_dwordx4 v[156:159], v6, s[12:15], s27 offen offset:0
    s_add_u32 s28, s28, 36864
    s_add_u32 s27, s27, 1024
    s_waitcnt vmcnt(28)
    v_mfma_f32_16x16x32_bf16 v[16:19], v[188:191], v[176:179], v[16:19]
    v_mfma_f32_16x16x32_bf16 v[20:23], v[188:191], v[180:183], v[20:23]
    v_mfma_f32_16x16x32_bf16 v[24:27], v[188:191], v[184:187], v[24:27]
    v_mfma_f32_16x16x32_bf16 v[28:31], v[192:195], v[176:179], v[28:31]
    v_mfma_f32_16x16x32_bf16 v[32:35], v[192:195], v[180:183], v[32:35]
    v_mfma_f32_16x16x32_bf16 v[36:39], v[192:195], v[184:187], v[36:39]
    v_mfma_f32_16x16x32_bf16 v[40:43], v[196:199], v[176:179], v[40:43]
    v_mfma_f32_16x16x32_bf16 v[44:47], v[196:199], v[180:183], v[44:47]
    v_mfma_f32_16x16x32_bf16 v[48:51], v[196:199], v[184:187], v[48:51]
    v_mfma_f32_16x16x32_bf16 v[52:55], v[200:203], v[176:179], v[52:55]
    v_mfma_f32_16x16x32_bf16 v[56:59], v[200:203], v[180:183], v[56:59]
    v_mfma_f32_16x16x32_bf16 v[60:63], v[200:203], v[184:187], v[60:63]
    buffer_load_dwordx4 v[188:191], v4, s[12:15], s28 offen offset:0
    buffer_load_dwordx4 v[192:195], v4, s[12:15], s28 offen offset:1024
    buffer_load_dwordx4 v[196:199], v4, s[12:15], s28 offen offset:2048
    buffer_load_dwordx4 v[200:203], v4, s[12:15], s28 offen offset:3072
    buffer_load_dwordx4 v[176:179], v4, s[12:15], s27 offen offset:0
    buffer_load_dwordx4 v[180:183], v5, s[12:15], s27 offen offset:0
    buffer_load_dwordx4 v[184:187], v6, s[12:15], s27 offen offset:0
    s_add_u32 s28, s28, 36864
    s_add_u32 s27, s27, 1024
    s_waitcnt vmcnt(28)
    v_mfma_f32_16x16x32_bf16 v[16:19], v[76:79], v[64:67], v[16:19]
    v_mfma_f32_16x16x32_bf16 v[20:23], v[76:79], v[68:71], v[20:23]
    v_mfma_f32_16x16x32_bf16 v[24:27], v[76:79], v[72:75], v[24:27]
    v_mfma_f32_16x16x32_bf16 v[28:31], v[80:83], v[64:67], v[28:31]
    v_mfma_f32_16x16x32_bf16 v[32:35], v[80:83], v[68:71], v[32:35]
    v_mfma_f32_16x16x32_bf16 v[36:39], v[80:83], v[72:75], v[36:39]
    v_mfma_f32_16x16x32_bf16 v[40:43], v[84:87], v[64:67], v[40:43]
    v_mfma_f32_16x16x32_bf16 v[44:47], v[84:87], v[68:71], v[44:47]
    v_mfma_f32_16x16x32_bf16 v[48:51], v[84:87], v[72:75], v[48:51]
    v_mfma_f32_16x16x32_bf16 v[52:55], v[88:91], v[64:67], v[52:55]
    v_mfma_f32_16x16x32_bf16 v[56:59], v[88:91], v[68:71], v[56:59]
    v_mfma_f32_16x16x32_bf16 v[60:63], v[88:91], v[72:75], v[60:63]
    buffer_load_dwordx4 v[76:79], v4, s[12:15], s28 offen offset:0
    buffer_load_dwordx4 v[80:83], v4, s[12:15], s28 offen offset:1024
    buffer_load_dwordx4 v[84:87], v4, s[12:15], s28 offen offset:2048
    buffer_load_dwordx4 v[88:91], v4, s[12:15], s28 offen offset:3072
    buffer_load_dwordx4 v[64:67], v4, s[12:15], s27 offen offset:0
    buffer_load_dwordx4 v[68:71], v5, s[12:15], s27 offen offset:0
    buffer_load_dwordx4 v[72:75], v6, s[12:15], s27 offen offset:0
    s_add_u32 s28, s28, 36864
    s_add_u32 s27, s27, 1024
    s_waitcnt vmcnt(28)
    v_mfma_f32_16x16x32_bf16 v[16:19], v[104:107], v[92:95], v[16:19]
    v_mfma_f32_16x16x32_bf16 v[20:23], v[104:107], v[96:99], v[20:23]
    v_mfma_f32_16x16x32_bf16 v[24:27], v[104:107], v[100:103], v[24:27]
    v_mfma_f32_16x16x32_bf16 v[28:31], v[108:111], v[92:95], v[28:31]
    v_mfma_f32_16x16x32_bf16 v[32:35], v[108:111], v[96:99], v[32:35]
    v_mfma_f32_16x16x32_bf16 v[36:39], v[108:111], v[100:103], v[36:39]
    v_mfma_f32_16x16x32_bf16 v[40:43], v[112:115], v[92:95], v[40:43]
    v_mfma_f32_16x16x32_bf16 v[44:47], v[112:115], v[96:99], v[44:47]
    v_mfma_f32_16x16x32_bf16 v[48:51], v[112:115], v[100:103], v[48:51]
    v_mfma_f32_16x16x32_bf16 v[52:55], v[116:119], v[92:95], v[52:55]
    v_mfma_f32_16x16x32_bf16 v[56:59], v[116:119], v[96:99], v[56:59]
    v_mfma_f32_16x16x32_bf16 v[60:63], v[116:119], v[100:103], v[60:63]
    buffer_load_dwordx4 v[104:107], v4, s[12:15], s28 offen offset:0
    buffer_load_dwordx4 v[108:111], v4, s[12:15], s28 offen offset:1024
    buffer_load_dwordx4 v[112:115], v4, s[12:15], s28 offen offset:2048
    buffer_load_dwordx4 v[116:119], v4, s[12:15], s28 offen offset:3072
    buffer_load_dwordx4 v[92:95], v4, s[12:15], s27 offen offset:0
    buffer_load_dwordx4 v[96:99], v5, s[12:15], s27 offen offset:0
    buffer_load_dwordx4 v[100:103], v6, s[12:15], s27 offen offset:0
    s_add_u32 s28, s28, 36864
    s_add_u32 s27, s27, 1024
    s_waitcnt vmcnt(28)
    v_mfma_f32_16x16x32_bf16 v[16:19], v[132:135], v[120:123], v[16:19]
    v_mfma_f32_16x16x32_bf16 v[20:23], v[132:135], v[124:127], v[20:23]
    v_mfma_f32_16x16x32_bf16 v[24:27], v[132:135], v[128:131], v[24:27]
    v_mfma_f32_16x16x32_bf16 v[28:31], v[136:139], v[120:123], v[28:31]
    v_mfma_f32_16x16x32_bf16 v[32:35], v[136:139], v[124:127], v[32:35]
    v_mfma_f32_16x16x32_bf16 v[36:39], v[136:139], v[128:131], v[36:39]
    v_mfma_f32_16x16x32_bf16 v[40:43], v[140:143], v[120:123], v[40:43]
    v_mfma_f32_16x16x32_bf16 v[44:47], v[140:143], v[124:127], v[44:47]
    v_mfma_f32_16x16x32_bf16 v[48:51], v[140:143], v[128:131], v[48:51]
    v_mfma_f32_16x16x32_bf16 v[52:55], v[144:147], v[120:123], v[52:55]
    v_mfma_f32_16x16x32_bf16 v[56:59], v[144:147], v[124:127], v[56:59]
    v_mfma_f32_16x16x32_bf16 v[60:63], v[144:147], v[128:131], v[60:63]
    buffer_load_dwordx4 v[132:135], v4, s[12:15], s28 offen offset:0
    buffer_load_dwordx4 v[136:139], v4, s[12:15], s28 offen offset:1024
    buffer_load_dwordx4 v[140:143], v4, s[12:15], s28 offen offset:2048
    buffer_load_dwordx4 v[144:147], v4, s[12:15], s28 offen offset:3072
    buffer_load_dwordx4 v[120:123], v4, s[12:15], s27 offen offset:0
    buffer_load_dwordx4 v[124:127], v5, s[12:15], s27 offen offset:0
    buffer_load_dwordx4 v[128:131], v6, s[12:15], s27 offen offset:0
    s_add_u32 s28, s28, 36864
    s_add_u32 s27, s27, 1024
    s_waitcnt vmcnt(28)
    v_mfma_f32_16x16x32_bf16 v[16:19], v[160:163], v[148:151], v[16:19]
    v_mfma_f32_16x16x32_bf16 v[20:23], v[160:163], v[152:155], v[20:23]
    v_mfma_f32_16x16x32_bf16 v[24:27], v[160:163], v[156:159], v[24:27]
    v_mfma_f32_16x16x32_bf16 v[28:31], v[164:167], v[148:151], v[28:31]
    v_mfma_f32_16x16x32_bf16 v[32:35], v[164:167], v[152:155], v[32:35]
    v_mfma_f32_16x16x32_bf16 v[36:39], v[164:167], v[156:159], v[36:39]
    v_mfma_f32_16x16x32_bf16 v[40:43], v[168:171], v[148:151], v[40:43]
    v_mfma_f32_16x16x32_bf16 v[44:47], v[168:171], v[152:155], v[44:47]
    v_mfma_f32_16x16x32_bf16 v[48:51], v[168:171], v[156:159], v[48:51]
    v_mfma_f32_16x16x32_bf16 v[52:55], v[172:175], v[148:151], v[52:55]
    v_mfma_f32_16x16x32_bf16 v[56:59], v[172:175], v[152:155], v[56:59]
    v_mfma_f32_16x16x32_bf16 v[60:63], v[172:175], v[156:159], v[60:63]
    buffer_load_dwordx4 v[160:163], v4, s[12:15], s28 offen offset:0
    buffer_load_dwordx4 v[164:167], v4, s[12:15], s28 offen offset:1024
    buffer_load_dwordx4 v[168:171], v4, s[12:15], s28 offen offset:2048
    buffer_load_dwordx4 v[172:175], v4, s[12:15], s28 offen offset:3072
    buffer_load_dwordx4 v[148:151], v4, s[12:15], s27 offen offset:0
    buffer_load_dwordx4 v[152:155], v5, s[12:15], s27 offen offset:0
    buffer_load_dwordx4 v[156:159], v6, s[12:15], s27 offen offset:0
    s_add_u32 s28, s28, 36864
    s_add_u32 s27, s27, 1024
    s_waitcnt vmcnt(28)
    v_mfma_f32_16x16x32_bf16 v[16:19], v[188:191], v[176:179], v[16:19]
    v_mfma_f32_16x16x32_bf16 v[20:23], v[188:191], v[180:183], v[20:23]
    v_mfma_f32_16x16x32_bf16 v[24:27], v[188:191], v[184:187], v[24:27]
    v_mfma_f32_16x16x32_bf16 v[28:31], v[192:195], v[176:179], v[28:31]
    v_mfma_f32_16x16x32_bf16 v[32:35], v[192:195], v[180:183], v[32:35]
    v_mfma_f32_16x16x32_bf16 v[36:39], v[192:195], v[184:187], v[36:39]
    v_mfma_f32_16x16x32_bf16 v[40:43], v[196:199], v[176:179], v[40:43]
    v_mfma_f32_16x16x32_bf16 v[44:47], v[196:199], v[180:183], v[44:47]
    v_mfma_f32_16x16x32_bf16 v[48:51], v[196:199], v[184:187], v[48:51]
    v_mfma_f32_16x16x32_bf16 v[52:55], v[200:203], v[176:179], v[52:55]
    v_mfma_f32_16x16x32_bf16 v[56:59], v[200:203], v[180:183], v[56:59]
    v_mfma_f32_16x16x32_bf16 v[60:63], v[200:203], v[184:187], v[60:63]
    buffer_load_dwordx4 v[188:191], v4, s[12:15], s28 offen offset:0
    buffer_load_dwordx4 v[192:195], v4, s[12:15], s28 offen offset:1024
    buffer_load_dwordx4 v[196:199], v4, s[12:15], s28 offen offset:2048
    buffer_load_dwordx4 v[200:203], v4, s[12:15], s28 offen offset:3072
    buffer_load_dwordx4 v[176:179], v4, s[12:15], s27 offen offset:0
    buffer_load_dwordx4 v[180:183], v5, s[12:15], s27 offen offset:0
    buffer_load_dwordx4 v[184:187], v6, s[12:15], s27 offen offset:0
    s_add_u32 s28, s28, 36864
    s_add_u32 s27, s27, 1024
    s_waitcnt vmcnt(28)
    v_mfma_f32_16x16x32_bf16 v[16:19], v[76:79], v[64:67], v[16:19]
    v_mfma_f32_16x16x32_bf16 v[20:23], v[76:79], v[68:71], v[20:23]
    v_mfma_f32_16x16x32_bf16 v[24:27], v[76:79], v[72:75], v[24:27]
    v_mfma_f32_16x16x32_bf16 v[28:31], v[80:83], v[64:67], v[28:31]
    v_mfma_f32_16x16x32_bf16 v[32:35], v[80:83], v[68:71], v[32:35]
    v_mfma_f32_16x16x32_bf16 v[36:39], v[80:83], v[72:75], v[36:39]
    v_mfma_f32_16x16x32_bf16 v[40:43], v[84:87], v[64:67], v[40:43]
    v_mfma_f32_16x16x32_bf16 v[44:47], v[84:87], v[68:71], v[44:47]
    v_mfma_f32_16x16x32_bf16 v[48:51], v[84:87], v[72:75], v[48:51]
    v_mfma_f32_16x16x32_bf16 v[52:55], v[88:91], v[64:67], v[52:55]
    v_mfma_f32_16x16x32_bf16 v[56:59], v[88:91], v[68:71], v[56:59]
    v_mfma_f32_16x16x32_bf16 v[60:63], v[88:91], v[72:75], v[60:63]
    buffer_load_dwordx4 v[76:79], v4, s[12:15], s28 offen offset:0
    buffer_load_dwordx4 v[80:83], v4, s[12:15], s28 offen offset:1024
    buffer_load_dwordx4 v[84:87], v4, s[12:15], s28 offen offset:2048
    buffer_load_dwordx4 v[88:91], v4, s[12:15], s28 offen offset:3072
    buffer_load_dwordx4 v[64:67], v4, s[12:15], s27 offen offset:0
    buffer_load_dwordx4 v[68:71], v5, s[12:15], s27 offen offset:0
    buffer_load_dwordx4 v[72:75], v6, s[12:15], s27 offen offset:0
    s_add_u32 s28, s28, 36864
    s_add_u32 s27, s27, 1024
    s_waitcnt vmcnt(28)
    v_mfma_f32_16x16x32_bf16 v[16:19], v[104:107], v[92:95], v[16:19]
    v_mfma_f32_16x16x32_bf16 v[20:23], v[104:107], v[96:99], v[20:23]
    v_mfma_f32_16x16x32_bf16 v[24:27], v[104:107], v[100:103], v[24:27]
    v_mfma_f32_16x16x32_bf16 v[28:31], v[108:111], v[92:95], v[28:31]
    v_mfma_f32_16x16x32_bf16 v[32:35], v[108:111], v[96:99], v[32:35]
    v_mfma_f32_16x16x32_bf16 v[36:39], v[108:111], v[100:103], v[36:39]
    v_mfma_f32_16x16x32_bf16 v[40:43], v[112:115], v[92:95], v[40:43]
    v_mfma_f32_16x16x32_bf16 v[44:47], v[112:115], v[96:99], v[44:47]
    v_mfma_f32_16x16x32_bf16 v[48:51], v[112:115], v[100:103], v[48:51]
    v_mfma_f32_16x16x32_bf16 v[52:55], v[116:119], v[92:95], v[52:55]
    v_mfma_f32_16x16x32_bf16 v[56:59], v[116:119], v[96:99], v[56:59]
    v_mfma_f32_16x16x32_bf16 v[60:63], v[116:119], v[100:103], v[60:63]
    buffer_load_dwordx4 v[104:107], v4, s[12:15], s28 offen offset:0
    buffer_load_dwordx4 v[108:111], v4, s[12:15], s28 offen offset:1024
    buffer_load_dwordx4 v[112:115], v4, s[12:15], s28 offen offset:2048
    buffer_load_dwordx4 v[116:119], v4, s[12:15], s28 offen offset:3072
    buffer_load_dwordx4 v[92:95], v4, s[12:15], s27 offen offset:0
    buffer_load_dwordx4 v[96:99], v5, s[12:15], s27 offen offset:0
    buffer_load_dwordx4 v[100:103], v6, s[12:15], s27 offen offset:0
    s_add_u32 s28, s28, 36864
    s_add_u32 s27, s27, 1024
    s_waitcnt vmcnt(28)
    v_mfma_f32_16x16x32_bf16 v[16:19], v[132:135], v[120:123], v[16:19]
    v_mfma_f32_16x16x32_bf16 v[20:23], v[132:135], v[124:127], v[20:23]
    v_mfma_f32_16x16x32_bf16 v[24:27], v[132:135], v[128:131], v[24:27]
    v_mfma_f32_16x16x32_bf16 v[28:31], v[136:139], v[120:123], v[28:31]
    v_mfma_f32_16x16x32_bf16 v[32:35], v[136:139], v[124:127], v[32:35]
    v_mfma_f32_16x16x32_bf16 v[36:39], v[136:139], v[128:131], v[36:39]
    v_mfma_f32_16x16x32_bf16 v[40:43], v[140:143], v[120:123], v[40:43]
    v_mfma_f32_16x16x32_bf16 v[44:47], v[140:143], v[124:127], v[44:47]
    v_mfma_f32_16x16x32_bf16 v[48:51], v[140:143], v[128:131], v[48:51]
    v_mfma_f32_16x16x32_bf16 v[52:55], v[144:147], v[120:123], v[52:55]
    v_mfma_f32_16x16x32_bf16 v[56:59], v[144:147], v[124:127], v[56:59]
    v_mfma_f32_16x16x32_bf16 v[60:63], v[144:147], v[128:131], v[60:63]
    buffer_load_dwordx4 v[132:135], v4, s[12:15], s28 offen offset:0
    buffer_load_dwordx4 v[136:139], v4, s[12:15], s28 offen offset:1024
    buffer_load_dwordx4 v[140:143], v4, s[12:15], s28 offen offset:2048
    buffer_load_dwordx4 v[144:147], v4, s[12:15], s28 offen offset:3072
    buffer_load_dwordx4 v[120:123], v4, s[12:15], s27 offen offset:0
    buffer_load_dwordx4 v[124:127], v5, s[12:15], s27 offen offset:0
    buffer_load_dwordx4 v[128:131], v6, s[12:15], s27 offen offset:0
    s_add_u32 s28, s28, 36864
    s_add_u32 s27, s27, 1024
    s_waitcnt vmcnt(28)
    v_mfma_f32_16x16x32_bf16 v[16:19], v[160:163], v[148:151], v[16:19]
    v_mfma_f32_16x16x32_bf16 v[20:23], v[160:163], v[152:155], v[20:23]
    v_mfma_f32_16x16x32_bf16 v[24:27], v[160:163], v[156:159], v[24:27]
    v_mfma_f32_16x16x32_bf16 v[28:31], v[164:167], v[148:151], v[28:31]
    v_mfma_f32_16x16x32_bf16 v[32:35], v[164:167], v[152:155], v[32:35]
    v_mfma_f32_16x16x32_bf16 v[36:39], v[164:167], v[156:159], v[36:39]
    v_mfma_f32_16x16x32_bf16 v[40:43], v[168:171], v[148:151], v[40:43]
    v_mfma_f32_16x16x32_bf16 v[44:47], v[168:171], v[152:155], v[44:47]
    v_mfma_f32_16x16x32_bf16 v[48:51], v[168:171], v[156:159], v[48:51]
    v_mfma_f32_16x16x32_bf16 v[52:55], v[172:175], v[148:151], v[52:55]
    v_mfma_f32_16x16x32_bf16 v[56:59], v[172:175], v[152:155], v[56:59]
    v_mfma_f32_16x16x32_bf16 v[60:63], v[172:175], v[156:159], v[60:63]
    buffer_load_dwordx4 v[160:163], v4, s[12:15], s28 offen offset:0
    buffer_load_dwordx4 v[164:167], v4, s[12:15], s28 offen offset:1024
    buffer_load_dwordx4 v[168:171], v4, s[12:15], s28 offen offset:2048
    buffer_load_dwordx4 v[172:175], v4, s[12:15], s28 offen offset:3072
    buffer_load_dwordx4 v[148:151], v4, s[12:15], s27 offen offset:0
    buffer_load_dwordx4 v[152:155], v5, s[12:15], s27 offen offset:0
    buffer_load_dwordx4 v[156:159], v6, s[12:15], s27 offen offset:0
    s_add_u32 s28, s28, 36864
    s_add_u32 s27, s27, 1024
    s_waitcnt vmcnt(28)
    v_mfma_f32_16x16x32_bf16 v[16:19], v[188:191], v[176:179], v[16:19]
    v_mfma_f32_16x16x32_bf16 v[20:23], v[188:191], v[180:183], v[20:23]
    v_mfma_f32_16x16x32_bf16 v[24:27], v[188:191], v[184:187], v[24:27]
    v_mfma_f32_16x16x32_bf16 v[28:31], v[192:195], v[176:179], v[28:31]
    v_mfma_f32_16x16x32_bf16 v[32:35], v[192:195], v[180:183], v[32:35]
    v_mfma_f32_16x16x32_bf16 v[36:39], v[192:195], v[184:187], v[36:39]
    v_mfma_f32_16x16x32_bf16 v[40:43], v[196:199], v[176:179], v[40:43]
    v_mfma_f32_16x16x32_bf16 v[44:47], v[196:199], v[180:183], v[44:47]
    v_mfma_f32_16x16x32_bf16 v[48:51], v[196:199], v[184:187], v[48:51]
    v_mfma_f32_16x16x32_bf16 v[52:55], v[200:203], v[176:179], v[52:55]
    v_mfma_f32_16x16x32_bf16 v[56:59], v[200:203], v[180:183], v[56:59]
    v_mfma_f32_16x16x32_bf16 v[60:63], v[200:203], v[184:187], v[60:63]
    buffer_load_dwordx4 v[188:191], v4, s[12:15], s28 offen offset:0
    buffer_load_dwordx4 v[192:195], v4, s[12:15], s28 offen offset:1024
    buffer_load_dwordx4 v[196:199], v4, s[12:15], s28 offen offset:2048
    buffer_load_dwordx4 v[200:203], v4, s[12:15], s28 offen offset:3072
    buffer_load_dwordx4 v[176:179], v4, s[12:15], s27 offen offset:0
    buffer_load_dwordx4 v[180:183], v5, s[12:15], s27 offen offset:0
    buffer_load_dwordx4 v[184:187], v6, s[12:15], s27 offen offset:0
    s_add_u32 s28, s28, 36864
    s_add_u32 s27, s27, 1024
    s_waitcnt vmcnt(28)
    v_mfma_f32_16x16x32_bf16 v[16:19], v[76:79], v[64:67], v[16:19]
    v_mfma_f32_16x16x32_bf16 v[20:23], v[76:79], v[68:71], v[20:23]
    v_mfma_f32_16x16x32_bf16 v[24:27], v[76:79], v[72:75], v[24:27]
    v_mfma_f32_16x16x32_bf16 v[28:31], v[80:83], v[64:67], v[28:31]
    v_mfma_f32_16x16x32_bf16 v[32:35], v[80:83], v[68:71], v[32:35]
    v_mfma_f32_16x16x32_bf16 v[36:39], v[80:83], v[72:75], v[36:39]
    v_mfma_f32_16x16x32_bf16 v[40:43], v[84:87], v[64:67], v[40:43]
    v_mfma_f32_16x16x32_bf16 v[44:47], v[84:87], v[68:71], v[44:47]
    v_mfma_f32_16x16x32_bf16 v[48:51], v[84:87], v[72:75], v[48:51]
    v_mfma_f32_16x16x32_bf16 v[52:55], v[88:91], v[64:67], v[52:55]
    v_mfma_f32_16x16x32_bf16 v[56:59], v[88:91], v[68:71], v[56:59]
    v_mfma_f32_16x16x32_bf16 v[60:63], v[88:91], v[72:75], v[60:63]
    buffer_load_dwordx4 v[76:79], v4, s[12:15], s28 offen offset:0
    buffer_load_dwordx4 v[80:83], v4, s[12:15], s28 offen offset:1024
    buffer_load_dwordx4 v[84:87], v4, s[12:15], s28 offen offset:2048
    buffer_load_dwordx4 v[88:91], v4, s[12:15], s28 offen offset:3072
    buffer_load_dwordx4 v[64:67], v4, s[12:15], s27 offen offset:0
    buffer_load_dwordx4 v[68:71], v5, s[12:15], s27 offen offset:0
    buffer_load_dwordx4 v[72:75], v6, s[12:15], s27 offen offset:0
    s_add_u32 s28, s28, 36864
    s_add_u32 s27, s27, 1024
    s_waitcnt vmcnt(28)
    v_mfma_f32_16x16x32_bf16 v[16:19], v[104:107], v[92:95], v[16:19]
    v_mfma_f32_16x16x32_bf16 v[20:23], v[104:107], v[96:99], v[20:23]
    v_mfma_f32_16x16x32_bf16 v[24:27], v[104:107], v[100:103], v[24:27]
    v_mfma_f32_16x16x32_bf16 v[28:31], v[108:111], v[92:95], v[28:31]
    v_mfma_f32_16x16x32_bf16 v[32:35], v[108:111], v[96:99], v[32:35]
    v_mfma_f32_16x16x32_bf16 v[36:39], v[108:111], v[100:103], v[36:39]
    v_mfma_f32_16x16x32_bf16 v[40:43], v[112:115], v[92:95], v[40:43]
    v_mfma_f32_16x16x32_bf16 v[44:47], v[112:115], v[96:99], v[44:47]
    v_mfma_f32_16x16x32_bf16 v[48:51], v[112:115], v[100:103], v[48:51]
    v_mfma_f32_16x16x32_bf16 v[52:55], v[116:119], v[92:95], v[52:55]
    v_mfma_f32_16x16x32_bf16 v[56:59], v[116:119], v[96:99], v[56:59]
    v_mfma_f32_16x16x32_bf16 v[60:63], v[116:119], v[100:103], v[60:63]
    buffer_load_dwordx4 v[104:107], v4, s[12:15], s28 offen offset:0
    buffer_load_dwordx4 v[108:111], v4, s[12:15], s28 offen offset:1024
    buffer_load_dwordx4 v[112:115], v4, s[12:15], s28 offen offset:2048
    buffer_load_dwordx4 v[116:119], v4, s[12:15], s28 offen offset:3072
    buffer_load_dwordx4 v[92:95], v4, s[12:15], s27 offen offset:0
    buffer_load_dwordx4 v[96:99], v5, s[12:15], s27 offen offset:0
    buffer_load_dwordx4 v[100:103], v6, s[12:15], s27 offen offset:0
    s_add_u32 s28, s28, 36864
    s_add_u32 s27, s27, 1024
    s_waitcnt vmcnt(28)
    v_mfma_f32_16x16x32_bf16 v[16:19], v[132:135], v[120:123], v[16:19]
    v_mfma_f32_16x16x32_bf16 v[20:23], v[132:135], v[124:127], v[20:23]
    v_mfma_f32_16x16x32_bf16 v[24:27], v[132:135], v[128:131], v[24:27]
    v_mfma_f32_16x16x32_bf16 v[28:31], v[136:139], v[120:123], v[28:31]
    v_mfma_f32_16x16x32_bf16 v[32:35], v[136:139], v[124:127], v[32:35]
    v_mfma_f32_16x16x32_bf16 v[36:39], v[136:139], v[128:131], v[36:39]
    v_mfma_f32_16x16x32_bf16 v[40:43], v[140:143], v[120:123], v[40:43]
    v_mfma_f32_16x16x32_bf16 v[44:47], v[140:143], v[124:127], v[44:47]
    v_mfma_f32_16x16x32_bf16 v[48:51], v[140:143], v[128:131], v[48:51]
    v_mfma_f32_16x16x32_bf16 v[52:55], v[144:147], v[120:123], v[52:55]
    v_mfma_f32_16x16x32_bf16 v[56:59], v[144:147], v[124:127], v[56:59]
    v_mfma_f32_16x16x32_bf16 v[60:63], v[144:147], v[128:131], v[60:63]
    buffer_load_dwordx4 v[132:135], v4, s[12:15], s28 offen offset:0
    buffer_load_dwordx4 v[136:139], v4, s[12:15], s28 offen offset:1024
    buffer_load_dwordx4 v[140:143], v4, s[12:15], s28 offen offset:2048
    buffer_load_dwordx4 v[144:147], v4, s[12:15], s28 offen offset:3072
    buffer_load_dwordx4 v[120:123], v4, s[12:15], s27 offen offset:0
    buffer_load_dwordx4 v[124:127], v5, s[12:15], s27 offen offset:0
    buffer_load_dwordx4 v[128:131], v6, s[12:15], s27 offen offset:0
    s_add_u32 s28, s28, 36864
    s_add_u32 s27, s27, 1024
    s_waitcnt vmcnt(28)
    v_mfma_f32_16x16x32_bf16 v[16:19], v[160:163], v[148:151], v[16:19]
    v_mfma_f32_16x16x32_bf16 v[20:23], v[160:163], v[152:155], v[20:23]
    v_mfma_f32_16x16x32_bf16 v[24:27], v[160:163], v[156:159], v[24:27]
    v_mfma_f32_16x16x32_bf16 v[28:31], v[164:167], v[148:151], v[28:31]
    v_mfma_f32_16x16x32_bf16 v[32:35], v[164:167], v[152:155], v[32:35]
    v_mfma_f32_16x16x32_bf16 v[36:39], v[164:167], v[156:159], v[36:39]
    v_mfma_f32_16x16x32_bf16 v[40:43], v[168:171], v[148:151], v[40:43]
    v_mfma_f32_16x16x32_bf16 v[44:47], v[168:171], v[152:155], v[44:47]
    v_mfma_f32_16x16x32_bf16 v[48:51], v[168:171], v[156:159], v[48:51]
    v_mfma_f32_16x16x32_bf16 v[52:55], v[172:175], v[148:151], v[52:55]
    v_mfma_f32_16x16x32_bf16 v[56:59], v[172:175], v[152:155], v[56:59]
    v_mfma_f32_16x16x32_bf16 v[60:63], v[172:175], v[156:159], v[60:63]
    buffer_load_dwordx4 v[160:163], v4, s[12:15], s28 offen offset:0
    buffer_load_dwordx4 v[164:167], v4, s[12:15], s28 offen offset:1024
    buffer_load_dwordx4 v[168:171], v4, s[12:15], s28 offen offset:2048
    buffer_load_dwordx4 v[172:175], v4, s[12:15], s28 offen offset:3072
    buffer_load_dwordx4 v[148:151], v4, s[12:15], s27 offen offset:0
    buffer_load_dwordx4 v[152:155], v5, s[12:15], s27 offen offset:0
    buffer_load_dwordx4 v[156:159], v6, s[12:15], s27 offen offset:0
    s_add_u32 s28, s28, 36864
    s_add_u32 s27, s27, 1024
    s_waitcnt vmcnt(28)
    v_mfma_f32_16x16x32_bf16 v[16:19], v[188:191], v[176:179], v[16:19]
    v_mfma_f32_16x16x32_bf16 v[20:23], v[188:191], v[180:183], v[20:23]
    v_mfma_f32_16x16x32_bf16 v[24:27], v[188:191], v[184:187], v[24:27]
    v_mfma_f32_16x16x32_bf16 v[28:31], v[192:195], v[176:179], v[28:31]
    v_mfma_f32_16x16x32_bf16 v[32:35], v[192:195], v[180:183], v[32:35]
    v_mfma_f32_16x16x32_bf16 v[36:39], v[192:195], v[184:187], v[36:39]
    v_mfma_f32_16x16x32_bf16 v[40:43], v[196:199], v[176:179], v[40:43]
    v_mfma_f32_16x16x32_bf16 v[44:47], v[196:199], v[180:183], v[44:47]
    v_mfma_f32_16x16x32_bf16 v[48:51], v[196:199], v[184:187], v[48:51]
    v_mfma_f32_16x16x32_bf16 v[52:55], v[200:203], v[176:179], v[52:55]
    v_mfma_f32_16x16x32_bf16 v[56:59], v[200:203], v[180:183], v[56:59]
    v_mfma_f32_16x16x32_bf16 v[60:63], v[200:203], v[184:187], v[60:63]
    buffer_load_dwordx4 v[188:191], v4, s[12:15], s28 offen offset:0
    buffer_load_dwordx4 v[192:195], v4, s[12:15], s28 offen offset:1024
    buffer_load_dwordx4 v[196:199], v4, s[12:15], s28 offen offset:2048
    buffer_load_dwordx4 v[200:203], v4, s[12:15], s28 offen offset:3072
    buffer_load_dwordx4 v[176:179], v4, s[12:15], s27 offen offset:0
    buffer_load_dwordx4 v[180:183], v5, s[12:15], s27 offen offset:0
    buffer_load_dwordx4 v[184:187], v6, s[12:15], s27 offen offset:0
    s_add_u32 s28, s28, 36864
    s_add_u32 s27, s27, 1024
    s_waitcnt vmcnt(28)
    v_mfma_f32_16x16x32_bf16 v[16:19], v[76:79], v[64:67], v[16:19]
    v_mfma_f32_16x16x32_bf16 v[20:23], v[76:79], v[68:71], v[20:23]
    v_mfma_f32_16x16x32_bf16 v[24:27], v[76:79], v[72:75], v[24:27]
    v_mfma_f32_16x16x32_bf16 v[28:31], v[80:83], v[64:67], v[28:31]
    v_mfma_f32_16x16x32_bf16 v[32:35], v[80:83], v[68:71], v[32:35]
    v_mfma_f32_16x16x32_bf16 v[36:39], v[80:83], v[72:75], v[36:39]
    v_mfma_f32_16x16x32_bf16 v[40:43], v[84:87], v[64:67], v[40:43]
    v_mfma_f32_16x16x32_bf16 v[44:47], v[84:87], v[68:71], v[44:47]
    v_mfma_f32_16x16x32_bf16 v[48:51], v[84:87], v[72:75], v[48:51]
    v_mfma_f32_16x16x32_bf16 v[52:55], v[88:91], v[64:67], v[52:55]
    v_mfma_f32_16x16x32_bf16 v[56:59], v[88:91], v[68:71], v[56:59]
    v_mfma_f32_16x16x32_bf16 v[60:63], v[88:91], v[72:75], v[60:63]
    buffer_load_dwordx4 v[76:79], v4, s[12:15], s28 offen offset:0
    buffer_load_dwordx4 v[80:83], v4, s[12:15], s28 offen offset:1024
    buffer_load_dwordx4 v[84:87], v4, s[12:15], s28 offen offset:2048
    buffer_load_dwordx4 v[88:91], v4, s[12:15], s28 offen offset:3072
    buffer_load_dwordx4 v[64:67], v4, s[12:15], s27 offen offset:0
    buffer_load_dwordx4 v[68:71], v5, s[12:15], s27 offen offset:0
    buffer_load_dwordx4 v[72:75], v6, s[12:15], s27 offen offset:0
    s_add_u32 s28, s28, 36864
    s_add_u32 s27, s27, 1024
    s_waitcnt vmcnt(28)
    v_mfma_f32_16x16x32_bf16 v[16:19], v[104:107], v[92:95], v[16:19]
    v_mfma_f32_16x16x32_bf16 v[20:23], v[104:107], v[96:99], v[20:23]
    v_mfma_f32_16x16x32_bf16 v[24:27], v[104:107], v[100:103], v[24:27]
    v_mfma_f32_16x16x32_bf16 v[28:31], v[108:111], v[92:95], v[28:31]
    v_mfma_f32_16x16x32_bf16 v[32:35], v[108:111], v[96:99], v[32:35]
    v_mfma_f32_16x16x32_bf16 v[36:39], v[108:111], v[100:103], v[36:39]
    v_mfma_f32_16x16x32_bf16 v[40:43], v[112:115], v[92:95], v[40:43]
    v_mfma_f32_16x16x32_bf16 v[44:47], v[112:115], v[96:99], v[44:47]
    v_mfma_f32_16x16x32_bf16 v[48:51], v[112:115], v[100:103], v[48:51]
    v_mfma_f32_16x16x32_bf16 v[52:55], v[116:119], v[92:95], v[52:55]
    v_mfma_f32_16x16x32_bf16 v[56:59], v[116:119], v[96:99], v[56:59]
    v_mfma_f32_16x16x32_bf16 v[60:63], v[116:119], v[100:103], v[60:63]
    buffer_load_dwordx4 v[104:107], v4, s[12:15], s28 offen offset:0
    buffer_load_dwordx4 v[108:111], v4, s[12:15], s28 offen offset:1024
    buffer_load_dwordx4 v[112:115], v4, s[12:15], s28 offen offset:2048
    buffer_load_dwordx4 v[116:119], v4, s[12:15], s28 offen offset:3072
    buffer_load_dwordx4 v[92:95], v4, s[12:15], s27 offen offset:0
    buffer_load_dwordx4 v[96:99], v5, s[12:15], s27 offen offset:0
    buffer_load_dwordx4 v[100:103], v6, s[12:15], s27 offen offset:0
    s_add_u32 s28, s28, 36864
    s_add_u32 s27, s27, 1024
    s_waitcnt vmcnt(28)
    v_mfma_f32_16x16x32_bf16 v[16:19], v[132:135], v[120:123], v[16:19]
    v_mfma_f32_16x16x32_bf16 v[20:23], v[132:135], v[124:127], v[20:23]
    v_mfma_f32_16x16x32_bf16 v[24:27], v[132:135], v[128:131], v[24:27]
    v_mfma_f32_16x16x32_bf16 v[28:31], v[136:139], v[120:123], v[28:31]
    v_mfma_f32_16x16x32_bf16 v[32:35], v[136:139], v[124:127], v[32:35]
    v_mfma_f32_16x16x32_bf16 v[36:39], v[136:139], v[128:131], v[36:39]
    v_mfma_f32_16x16x32_bf16 v[40:43], v[140:143], v[120:123], v[40:43]
    v_mfma_f32_16x16x32_bf16 v[44:47], v[140:143], v[124:127], v[44:47]
    v_mfma_f32_16x16x32_bf16 v[48:51], v[140:143], v[128:131], v[48:51]
    v_mfma_f32_16x16x32_bf16 v[52:55], v[144:147], v[120:123], v[52:55]
    v_mfma_f32_16x16x32_bf16 v[56:59], v[144:147], v[124:127], v[56:59]
    v_mfma_f32_16x16x32_bf16 v[60:63], v[144:147], v[128:131], v[60:63]
    buffer_load_dwordx4 v[132:135], v4, s[12:15], s28 offen offset:0
    buffer_load_dwordx4 v[136:139], v4, s[12:15], s28 offen offset:1024
    buffer_load_dwordx4 v[140:143], v4, s[12:15], s28 offen offset:2048
    buffer_load_dwordx4 v[144:147], v4, s[12:15], s28 offen offset:3072
    buffer_load_dwordx4 v[120:123], v4, s[12:15], s27 offen offset:0
    buffer_load_dwordx4 v[124:127], v5, s[12:15], s27 offen offset:0
    buffer_load_dwordx4 v[128:131], v6, s[12:15], s27 offen offset:0
    s_add_u32 s28, s28, 36864
    s_add_u32 s27, s27, 1024
    s_waitcnt vmcnt(28)
    v_mfma_f32_16x16x32_bf16 v[16:19], v[160:163], v[148:151], v[16:19]
    v_mfma_f32_16x16x32_bf16 v[20:23], v[160:163], v[152:155], v[20:23]
    v_mfma_f32_16x16x32_bf16 v[24:27], v[160:163], v[156:159], v[24:27]
    v_mfma_f32_16x16x32_bf16 v[28:31], v[164:167], v[148:151], v[28:31]
    v_mfma_f32_16x16x32_bf16 v[32:35], v[164:167], v[152:155], v[32:35]
    v_mfma_f32_16x16x32_bf16 v[36:39], v[164:167], v[156:159], v[36:39]
    v_mfma_f32_16x16x32_bf16 v[40:43], v[168:171], v[148:151], v[40:43]
    v_mfma_f32_16x16x32_bf16 v[44:47], v[168:171], v[152:155], v[44:47]
    v_mfma_f32_16x16x32_bf16 v[48:51], v[168:171], v[156:159], v[48:51]
    v_mfma_f32_16x16x32_bf16 v[52:55], v[172:175], v[148:151], v[52:55]
    v_mfma_f32_16x16x32_bf16 v[56:59], v[172:175], v[152:155], v[56:59]
    v_mfma_f32_16x16x32_bf16 v[60:63], v[172:175], v[156:159], v[60:63]
    buffer_load_dwordx4 v[160:163], v4, s[12:15], s28 offen offset:0
    buffer_load_dwordx4 v[164:167], v4, s[12:15], s28 offen offset:1024
    buffer_load_dwordx4 v[168:171], v4, s[12:15], s28 offen offset:2048
    buffer_load_dwordx4 v[172:175], v4, s[12:15], s28 offen offset:3072
    buffer_load_dwordx4 v[148:151], v4, s[12:15], s27 offen offset:0
    buffer_load_dwordx4 v[152:155], v5, s[12:15], s27 offen offset:0
    buffer_load_dwordx4 v[156:159], v6, s[12:15], s27 offen offset:0
    s_add_u32 s28, s28, 36864
    s_add_u32 s27, s27, 1024
    s_waitcnt vmcnt(28)
    v_mfma_f32_16x16x32_bf16 v[16:19], v[188:191], v[176:179], v[16:19]
    v_mfma_f32_16x16x32_bf16 v[20:23], v[188:191], v[180:183], v[20:23]
    v_mfma_f32_16x16x32_bf16 v[24:27], v[188:191], v[184:187], v[24:27]
    v_mfma_f32_16x16x32_bf16 v[28:31], v[192:195], v[176:179], v[28:31]
    v_mfma_f32_16x16x32_bf16 v[32:35], v[192:195], v[180:183], v[32:35]
    v_mfma_f32_16x16x32_bf16 v[36:39], v[192:195], v[184:187], v[36:39]
    v_mfma_f32_16x16x32_bf16 v[40:43], v[196:199], v[176:179], v[40:43]
    v_mfma_f32_16x16x32_bf16 v[44:47], v[196:199], v[180:183], v[44:47]
    v_mfma_f32_16x16x32_bf16 v[48:51], v[196:199], v[184:187], v[48:51]
    v_mfma_f32_16x16x32_bf16 v[52:55], v[200:203], v[176:179], v[52:55]
    v_mfma_f32_16x16x32_bf16 v[56:59], v[200:203], v[180:183], v[56:59]
    v_mfma_f32_16x16x32_bf16 v[60:63], v[200:203], v[184:187], v[60:63]
    buffer_load_dwordx4 v[188:191], v4, s[12:15], s28 offen offset:0
    buffer_load_dwordx4 v[192:195], v4, s[12:15], s28 offen offset:1024
    buffer_load_dwordx4 v[196:199], v4, s[12:15], s28 offen offset:2048
    buffer_load_dwordx4 v[200:203], v4, s[12:15], s28 offen offset:3072
    buffer_load_dwordx4 v[176:179], v4, s[12:15], s27 offen offset:0
    buffer_load_dwordx4 v[180:183], v5, s[12:15], s27 offen offset:0
    buffer_load_dwordx4 v[184:187], v6, s[12:15], s27 offen offset:0
    s_add_u32 s28, s28, 36864
    s_add_u32 s27, s27, 1024
    s_waitcnt vmcnt(28)
    v_mfma_f32_16x16x32_bf16 v[16:19], v[76:79], v[64:67], v[16:19]
    v_mfma_f32_16x16x32_bf16 v[20:23], v[76:79], v[68:71], v[20:23]
    v_mfma_f32_16x16x32_bf16 v[24:27], v[76:79], v[72:75], v[24:27]
    v_mfma_f32_16x16x32_bf16 v[28:31], v[80:83], v[64:67], v[28:31]
    v_mfma_f32_16x16x32_bf16 v[32:35], v[80:83], v[68:71], v[32:35]
    v_mfma_f32_16x16x32_bf16 v[36:39], v[80:83], v[72:75], v[36:39]
    v_mfma_f32_16x16x32_bf16 v[40:43], v[84:87], v[64:67], v[40:43]
    v_mfma_f32_16x16x32_bf16 v[44:47], v[84:87], v[68:71], v[44:47]
    v_mfma_f32_16x16x32_bf16 v[48:51], v[84:87], v[72:75], v[48:51]
    v_mfma_f32_16x16x32_bf16 v[52:55], v[88:91], v[64:67], v[52:55]
    v_mfma_f32_16x16x32_bf16 v[56:59], v[88:91], v[68:71], v[56:59]
    v_mfma_f32_16x16x32_bf16 v[60:63], v[88:91], v[72:75], v[60:63]
    buffer_load_dwordx4 v[76:79], v4, s[12:15], s28 offen offset:0
    buffer_load_dwordx4 v[80:83], v4, s[12:15], s28 offen offset:1024
    buffer_load_dwordx4 v[84:87], v4, s[12:15], s28 offen offset:2048
    buffer_load_dwordx4 v[88:91], v4, s[12:15], s28 offen offset:3072
    buffer_load_dwordx4 v[64:67], v4, s[12:15], s27 offen offset:0
    buffer_load_dwordx4 v[68:71], v5, s[12:15], s27 offen offset:0
    buffer_load_dwordx4 v[72:75], v6, s[12:15], s27 offen offset:0
    s_add_u32 s28, s28, 36864
    s_add_u32 s27, s27, 1024
    s_waitcnt vmcnt(28)
    v_mfma_f32_16x16x32_bf16 v[16:19], v[104:107], v[92:95], v[16:19]
    v_mfma_f32_16x16x32_bf16 v[20:23], v[104:107], v[96:99], v[20:23]
    v_mfma_f32_16x16x32_bf16 v[24:27], v[104:107], v[100:103], v[24:27]
    v_mfma_f32_16x16x32_bf16 v[28:31], v[108:111], v[92:95], v[28:31]
    v_mfma_f32_16x16x32_bf16 v[32:35], v[108:111], v[96:99], v[32:35]
    v_mfma_f32_16x16x32_bf16 v[36:39], v[108:111], v[100:103], v[36:39]
    v_mfma_f32_16x16x32_bf16 v[40:43], v[112:115], v[92:95], v[40:43]
    v_mfma_f32_16x16x32_bf16 v[44:47], v[112:115], v[96:99], v[44:47]
    v_mfma_f32_16x16x32_bf16 v[48:51], v[112:115], v[100:103], v[48:51]
    v_mfma_f32_16x16x32_bf16 v[52:55], v[116:119], v[92:95], v[52:55]
    v_mfma_f32_16x16x32_bf16 v[56:59], v[116:119], v[96:99], v[56:59]
    v_mfma_f32_16x16x32_bf16 v[60:63], v[116:119], v[100:103], v[60:63]
    buffer_load_dwordx4 v[104:107], v4, s[12:15], s28 offen offset:0
    buffer_load_dwordx4 v[108:111], v4, s[12:15], s28 offen offset:1024
    buffer_load_dwordx4 v[112:115], v4, s[12:15], s28 offen offset:2048
    buffer_load_dwordx4 v[116:119], v4, s[12:15], s28 offen offset:3072
    buffer_load_dwordx4 v[92:95], v4, s[12:15], s27 offen offset:0
    buffer_load_dwordx4 v[96:99], v5, s[12:15], s27 offen offset:0
    buffer_load_dwordx4 v[100:103], v6, s[12:15], s27 offen offset:0
    s_add_u32 s28, s28, 36864
    s_add_u32 s27, s27, 1024
    s_waitcnt vmcnt(28)
    v_mfma_f32_16x16x32_bf16 v[16:19], v[132:135], v[120:123], v[16:19]
    v_mfma_f32_16x16x32_bf16 v[20:23], v[132:135], v[124:127], v[20:23]
    v_mfma_f32_16x16x32_bf16 v[24:27], v[132:135], v[128:131], v[24:27]
    v_mfma_f32_16x16x32_bf16 v[28:31], v[136:139], v[120:123], v[28:31]
    v_mfma_f32_16x16x32_bf16 v[32:35], v[136:139], v[124:127], v[32:35]
    v_mfma_f32_16x16x32_bf16 v[36:39], v[136:139], v[128:131], v[36:39]
    v_mfma_f32_16x16x32_bf16 v[40:43], v[140:143], v[120:123], v[40:43]
    v_mfma_f32_16x16x32_bf16 v[44:47], v[140:143], v[124:127], v[44:47]
    v_mfma_f32_16x16x32_bf16 v[48:51], v[140:143], v[128:131], v[48:51]
    v_mfma_f32_16x16x32_bf16 v[52:55], v[144:147], v[120:123], v[52:55]
    v_mfma_f32_16x16x32_bf16 v[56:59], v[144:147], v[124:127], v[56:59]
    v_mfma_f32_16x16x32_bf16 v[60:63], v[144:147], v[128:131], v[60:63]
    s_waitcnt vmcnt(21)
    v_mfma_f32_16x16x32_bf16 v[16:19], v[160:163], v[148:151], v[16:19]
    v_mfma_f32_16x16x32_bf16 v[20:23], v[160:163], v[152:155], v[20:23]
    v_mfma_f32_16x16x32_bf16 v[24:27], v[160:163], v[156:159], v[24:27]
    v_mfma_f32_16x16x32_bf16 v[28:31], v[164:167], v[148:151], v[28:31]
    v_mfma_f32_16x16x32_bf16 v[32:35], v[164:167], v[152:155], v[32:35]
    v_mfma_f32_16x16x32_bf16 v[36:39], v[164:167], v[156:159], v[36:39]
    v_mfma_f32_16x16x32_bf16 v[40:43], v[168:171], v[148:151], v[40:43]
    v_mfma_f32_16x16x32_bf16 v[44:47], v[168:171], v[152:155], v[44:47]
    v_mfma_f32_16x16x32_bf16 v[48:51], v[168:171], v[156:159], v[48:51]
    v_mfma_f32_16x16x32_bf16 v[52:55], v[172:175], v[148:151], v[52:55]
    v_mfma_f32_16x16x32_bf16 v[56:59], v[172:175], v[152:155], v[56:59]
    v_mfma_f32_16x16x32_bf16 v[60:63], v[172:175], v[156:159], v[60:63]
    s_waitcnt vmcnt(14)
    v_mfma_f32_16x16x32_bf16 v[16:19], v[188:191], v[176:179], v[16:19]
    v_mfma_f32_16x16x32_bf16 v[20:23], v[188:191], v[180:183], v[20:23]
    v_mfma_f32_16x16x32_bf16 v[24:27], v[188:191], v[184:187], v[24:27]
    v_mfma_f32_16x16x32_bf16 v[28:31], v[192:195], v[176:179], v[28:31]
    v_mfma_f32_16x16x32_bf16 v[32:35], v[192:195], v[180:183], v[32:35]
    v_mfma_f32_16x16x32_bf16 v[36:39], v[192:195], v[184:187], v[36:39]
    v_mfma_f32_16x16x32_bf16 v[40:43], v[196:199], v[176:179], v[40:43]
    v_mfma_f32_16x16x32_bf16 v[44:47], v[196:199], v[180:183], v[44:47]
    v_mfma_f32_16x16x32_bf16 v[48:51], v[196:199], v[184:187], v[48:51]
    v_mfma_f32_16x16x32_bf16 v[52:55], v[200:203], v[176:179], v[52:55]
    v_mfma_f32_16x16x32_bf16 v[56:59], v[200:203], v[180:183], v[56:59]
    v_mfma_f32_16x16x32_bf16 v[60:63], v[200:203], v[184:187], v[60:63]
    s_waitcnt vmcnt(7)
    v_mfma_f32_16x16x32_bf16 v[16:19], v[76:79], v[64:67], v[16:19]
    v_mfma_f32_16x16x32_bf16 v[20:23], v[76:79], v[68:71], v[20:23]
    v_mfma_f32_16x16x32_bf16 v[24:27], v[76:79], v[72:75], v[24:27]
    v_mfma_f32_16x16x32_bf16 v[28:31], v[80:83], v[64:67], v[28:31]
    v_mfma_f32_16x16x32_bf16 v[32:35], v[80:83], v[68:71], v[32:35]
    v_mfma_f32_16x16x32_bf16 v[36:39], v[80:83], v[72:75], v[36:39]
    v_mfma_f32_16x16x32_bf16 v[40:43], v[84:87], v[64:67], v[40:43]
    v_mfma_f32_16x16x32_bf16 v[44:47], v[84:87], v[68:71], v[44:47]
    v_mfma_f32_16x16x32_bf16 v[48:51], v[84:87], v[72:75], v[48:51]
    v_mfma_f32_16x16x32_bf16 v[52:55], v[88:91], v[64:67], v[52:55]
    v_mfma_f32_16x16x32_bf16 v[56:59], v[88:91], v[68:71], v[56:59]
    v_mfma_f32_16x16x32_bf16 v[60:63], v[88:91], v[72:75], v[60:63]
    s_waitcnt vmcnt(0)
    v_mfma_f32_16x16x32_bf16 v[16:19], v[104:107], v[92:95], v[16:19]
    v_mfma_f32_16x16x32_bf16 v[20:23], v[104:107], v[96:99], v[20:23]
    v_mfma_f32_16x16x32_bf16 v[24:27], v[104:107], v[100:103], v[24:27]
    v_mfma_f32_16x16x32_bf16 v[28:31], v[108:111], v[92:95], v[28:31]
    v_mfma_f32_16x16x32_bf16 v[32:35], v[108:111], v[96:99], v[32:35]
    v_mfma_f32_16x16x32_bf16 v[36:39], v[108:111], v[100:103], v[36:39]
    v_mfma_f32_16x16x32_bf16 v[40:43], v[112:115], v[92:95], v[40:43]
    v_mfma_f32_16x16x32_bf16 v[44:47], v[112:115], v[96:99], v[44:47]
    v_mfma_f32_16x16x32_bf16 v[48:51], v[112:115], v[100:103], v[48:51]
    v_mfma_f32_16x16x32_bf16 v[52:55], v[116:119], v[92:95], v[52:55]
    v_mfma_f32_16x16x32_bf16 v[56:59], v[116:119], v[96:99], v[56:59]
    v_mfma_f32_16x16x32_bf16 v[60:63], v[116:119], v[100:103], v[60:63]
    v_and_b32 v2, 15, v1
    v_mul_u32_u24 v2, 272, v2
    v_lshrrev_b32 v3, 4, v1
    v_lshlrev_b32 v3, 4, v3
    v_add_u32 v2, v2, v3
    s_mul_i32 s30, s26, 13056
    v_add_u32 v2, s30, v2
    ds_write_b128 v2, v[16:19] offset:0
    ds_write_b128 v2, v[20:23] offset:4352
    ds_write_b128 v2, v[24:27] offset:8704
    ds_write_b128 v2, v[28:31] offset:64
    ds_write_b128 v2, v[32:35] offset:4416
    ds_write_b128 v2, v[36:39] offset:8768
    ds_write_b128 v2, v[40:43] offset:128
    ds_write_b128 v2, v[44:47] offset:4480
    ds_write_b128 v2, v[48:51] offset:8832
    ds_write_b128 v2, v[52:55] offset:192
    ds_write_b128 v2, v[56:59] offset:4544
    ds_write_b128 v2, v[60:63] offset:8896
    s_waitcnt lgkmcnt(0)
    s_barrier
    v_lshrrev_b32 v2, 4, v0
    v_and_b32 v3, 15, v0
    v_mul_u32_u24 v4, 272, v2
    v_lshlrev_b32 v5, 4, v3
    v_add_u32 v4, v4, v5
    ds_read_b128 v[64:67], v4 offset:0
    ds_read_b128 v[68:71], v4 offset:13056
    ds_read_b128 v[72:75], v4 offset:26112
    ds_read_b128 v[76:79], v4 offset:39168
    ds_read_b128 v[80:83], v4 offset:4352
    ds_read_b128 v[84:87], v4 offset:17408
    ds_read_b128 v[88:91], v4 offset:30464
    ds_read_b128 v[92:95], v4 offset:43520
    ds_read_b128 v[96:99], v4 offset:8704
    ds_read_b128 v[100:103], v4 offset:21760
    ds_read_b128 v[104:107], v4 offset:34816
    ds_read_b128 v[108:111], v4 offset:47872
    s_mul_i32 s30, s22, 144
    s_mul_i32 s31, s25, 48
    s_add_u32 s30, s30, s31
    s_mul_i32 s30, s30, 1152
    s_lshl_b32 s31, s24, 7
    s_add_u32 s30, s30, s31
    v_mul_u32_u24 v5, 1152, v2
    v_lshlrev_b32 v6, 3, v3
    v_add_u32 v5, v5, v6
    s_waitcnt lgkmcnt(8)
    v_add_f32 v64, v64, v68
    v_add_f32 v72, v72, v76
    v_add_f32 v65, v65, v69
    v_add_f32 v73, v73, v77
    v_add_f32 v66, v66, v70
    v_add_f32 v74, v74, v78
    v_add_f32 v67, v67, v71
    v_add_f32 v75, v75, v79
    v_add_f32 v64, v64, v72
    v_add_f32 v65, v65, v73
    v_add_f32 v66, v66, v74
    v_add_f32 v67, v67, v75
    v_cvt_pk_bf16_f32 v68, v64, v65
    v_cvt_pk_bf16_f32 v69, v66, v67
    buffer_store_dwordx2 v[68:69], v5, s[16:19], s30 offen offset:0
    s_waitcnt lgkmcnt(4)
    v_add_f32 v80, v80, v84
    v_add_f32 v88, v88, v92
    v_add_f32 v81, v81, v85
    v_add_f32 v89, v89, v93
    v_add_f32 v82, v82, v86
    v_add_f32 v90, v90, v94
    v_add_f32 v83, v83, v87
    v_add_f32 v91, v91, v95
    v_add_f32 v80, v80, v88
    v_add_f32 v81, v81, v89
    v_add_f32 v82, v82, v90
    v_add_f32 v83, v83, v91
    v_cvt_pk_bf16_f32 v84, v80, v81
    v_cvt_pk_bf16_f32 v85, v82, v83
    v_add_u32 v5, 18432, v5
    buffer_store_dwordx2 v[84:85], v5, s[16:19], s30 offen offset:0
    s_waitcnt lgkmcnt(0)
    v_add_f32 v96, v96, v100
    v_add_f32 v104, v104, v108
    v_add_f32 v97, v97, v101
    v_add_f32 v105, v105, v109
    v_add_f32 v98, v98, v102
    v_add_f32 v106, v106, v110
    v_add_f32 v99, v99, v103
    v_add_f32 v107, v107, v111
    v_add_f32 v96, v96, v104
    v_add_f32 v97, v97, v105
    v_add_f32 v98, v98, v106
    v_add_f32 v99, v99, v107
    v_cvt_pk_bf16_f32 v100, v96, v97
    v_cvt_pk_bf16_f32 v101, v98, v99
    v_add_u32 v5, 18432, v5
    buffer_store_dwordx2 v[100:101], v5, s[16:19], s30 offen offset:0
oproj_kernel_done:
    s_endpgm
.section .rodata,"a"
.p2align 6
.amdhsa_kernel attn_kernel
  .amdhsa_next_free_vgpr 256
  .amdhsa_next_free_sgpr 64
  .amdhsa_accum_offset 256
  .amdhsa_group_segment_fixed_size 0
  .amdhsa_kernarg_size 64
  .amdhsa_user_sgpr_count 2
  .amdhsa_user_sgpr_kernarg_segment_ptr 1
  .amdhsa_system_sgpr_workgroup_id_x 1
.end_amdhsa_kernel
.p2align 6
.amdhsa_kernel oproj_kernel
  .amdhsa_next_free_vgpr 208
  .amdhsa_next_free_sgpr 64
  .amdhsa_accum_offset 208
  .amdhsa_group_segment_fixed_size 0
  .amdhsa_kernarg_size 64
  .amdhsa_user_sgpr_count 2
  .amdhsa_user_sgpr_kernarg_segment_ptr 1
  .amdhsa_system_sgpr_workgroup_id_x 1
.end_amdhsa_kernel
```
